```python
import torch

def _softmax(x, axis=-1):
    return torch.softmax(x, dim=axis)

def _gelu(x):
    return torch.nn.functional.gelu(x, approximate='tanh')

def _silu(x):
    return torch.nn.functional.silu(x)

def _sigmoid(x):
    return torch.sigmoid(x)

def _layernorm(x, axis=-1, eps=1e-05):
    m = x.mean(dim=axis, keepdim=True)
    v = x.var(dim=axis, keepdim=True, unbiased=False)
    return (x - m) / torch.sqrt(v + eps)

def _scatter_add(tgt, idx, src, axis=0):
    return tgt.clone().index_add_(axis, idx, src)

def _segment_sum(src, seg, n):
    out = torch.zeros((n,) + src.shape[1:], dtype=src.dtype)
    return out.index_add_(0, seg, src)

def _pad(x, pw):
    flat = tuple((v for pair in reversed(pw) for v in pair))
    return torch.nn.functional.pad(x, flat)
kernel_name = 'gather_scatter__tensor_product_equiv_equiformer__graph'

def setup_inputs():

    _w = lambda a: (lambda t: t.to(torch.bfloat16) if t.is_floating_point() else t)(torch.as_tensor(a))
    N, deg, C, De = (10000, 32, 128, max(0, 1))
    E = N * deg
    src = (lambda lo, hi, *s: torch.randint(lo, hi, s))(0, N, E).to(torch.int64)
    dst = (lambda lo, hi, *s: torch.randint(lo, hi, s))(0, N, E).to(torch.int64)
    rvec = (lambda *s: torch.randn(*s, dtype=torch.bfloat16) * 0.05)(E, 3).to(float)
    rn = (torch.linalg.norm(rvec, dim=-1, keepdim=True) + 1e-06).to(float)
    rhat = (rvec / rn).to(float)
    eps = torch.zeros((3, 3, 3), dtype=float)
    eps[0, 1, 2] = eps[1, 2, 0] = eps[2, 0, 1] = 1.0
    eps[0, 2, 1] = eps[2, 1, 0] = eps[1, 0, 2] = -1.0
    return {'x': _w((lambda *s: torch.randn(*s, dtype=torch.bfloat16) * 0.4)(N, 4 * C).to(float)), 'rhat': _w(rhat), 'e_attr': _w((lambda *s: torch.randn(*s, dtype=torch.bfloat16) * 0.4)(E, De).to(float)), 'src': _w(src), 'dst': _w(dst), 'w_rad': _w((lambda *s: torch.randn(*s, dtype=torch.bfloat16) * 0.4)(De, 5 * C).to(float)), 'w_si0': _w((lambda *s: torch.randn(*s, dtype=torch.bfloat16) * 0.4)(2 * C, C).to(float)), 'w_si1': _w((lambda *s: torch.randn(*s, dtype=torch.bfloat16) * 0.05)(3 * C, C).to(float)), 'cg_eps': _w(eps)}

def reference(x, rhat, e_attr, src, dst, w_rad, w_si0, w_si1, cg_eps):
    N = x.shape[0]
    C = w_si0.shape[1]
    E = rhat.shape[0]
    x0 = x[:, :C].clone()
    x1 = x[:, C:].reshape(N, 3, C)
    R = (e_attr @ w_rad).reshape(E, 5, C)
    f0 = x0[src]
    f1 = x1[src]
    Y1 = rhat
    p00_0 = f0 * R[:, 0, :]
    p11_0 = torch.einsum('ejc,ej->ec', f1, Y1) * R[:, 1, :]
    p01_1 = torch.einsum('ec,ej->ejc', f0, Y1) * R[:, 2, :][:, None, :]
    p10_1 = f1 * R[:, 3, :][:, None, :]
    p11_1 = torch.einsum('ijk,ekc,ej->eic', cg_eps, f1, Y1) * R[:, 4, :][:, None, :]
    m0 = torch.concatenate([p00_0, p11_0], axis=-1) @ w_si0
    m1 = torch.einsum('ejp,pc->ejc', torch.concatenate([p01_1, p10_1, p11_1], axis=-1), w_si1)
    agg0 = _segment_sum(m0, dst, N)
    agg1 = _segment_sum(m1.reshape(E, 3 * C), dst, N).reshape(N, 3, C)
    gate = _sigmoid(agg0)
    out1 = agg1 * gate[:, None, :]
    return torch.concatenate([agg0, out1.reshape(N, 3 * C)], axis=-1)
```

```asm
; @launch grid=(256,1,1) block=(512,1,1) lds=160768
.amdgcn_target "amdgcn-amd-amdhsa--gfx950"
.text
.globl gather_scatter__tensor_product_equiv_equiformer__graph_kernel
.p2align 8
.type gather_scatter__tensor_product_equiv_equiformer__graph_kernel,@function
gather_scatter__tensor_product_equiv_equiformer__graph_kernel:
    s_cmpk_ge_u32 s2, 256
    s_cbranch_scc1 L2_end
    s_load_dwordx16 s[20:35], s[0:1], 0
    s_getpc_b64 s[4:5]
    s_lshr_b32 s6, s2, 3
    s_mulk_i32 s6, 896
    s_add_u32 s4, s4, s6
    s_addc_u32 s5, s5, 0
    v_mov_b32 v1, 0
    v_cmp_gt_u32 vcc, 7, v0
    v_lshlrev_b64 v[2:3], 3, v[0:1]
    v_lshl_add_u64 v[2:3], v[2:3], 4, s[4:5]
    s_and_saveexec_b64 s[4:5], vcc
    s_cbranch_execz L0_nc
    global_load_dword v223, v[2:3], off offset:128
L0_nc:
    s_mov_b64 exec, -1
    s_load_dwordx4 s[36:39], s[0:1], 80
    s_load_dwordx2 s[12:13], s[0:1], 72
    s_memrealtime s[60:61]
    v_mov_b32 v252, v0
    v_lshrrev_b32 v1, 6, v0
    v_and_b32 v4, 63, v0
    s_and_b32 s4, s2, 7
    s_lshr_b32 s5, s2, 3
    v_readfirstlane_b32 s17, v1
    s_lshl_b32 s16, s4, 5
    s_add_u32 s16, s16, s5
    s_min_u32 s3, s2, 249
    s_mul_i32 s4, s3, 320
    s_mul_i32 s5, s17, 40
    s_add_u32 s4, s4, s5
    v_add_u32 v5, s4, v4
    v_lshlrev_b32 v1, 4, v5
    v_mul_u32_u24 v2, 24, v5
    v_lshlrev_b32 v3, 3, v5
    v_lshlrev_b32 v72, 6, v5
    v_and_b32 v6, 255, v0
    v_lshlrev_b32 v6, 2, v6
    v_mov_b32 v73, 0
    ds_write_b32 v6, v73 offset:0
    s_mov_b32 s46, -1
    s_mov_b32 s47, 0xff
    v_mov_b32 v66, 26843544
    s_mov_b32 s7, 0xb780
    v_mov_b32 v5, 1
    s_mov_b64 exec, s[46:47]
    s_waitcnt lgkmcnt(0)
    global_load_dwordx4 v[8:11], v1, s[28:29]
    s_mov_b64 exec, -1
    s_cmp_lg_u32 s17, 7
    s_cbranch_scc1 L1_a
    s_cmp_lt_u32 s2, 250
    s_cbranch_scc1 L1_a
    s_and_b32 s61, s61, 0x3ff
    s_bitset1_b32 s61, 31
    v_mov_b32 v76, s60
    v_mov_b32 v77, s61
    v_mov_b32 v78, 0
    v_mov_b32 v79, 0
    s_mov_b64 exec, 1
    global_atomic_cmpswap_x2 v73, v[76:79], s[36:37] sc1
    s_mov_b64 exec, -1
L1_a:
    s_barrier
    s_mov_b64 exec, s[46:47]
    global_load_dwordx4 v[12:15], v1, s[26:27]
    global_load_dwordx4 v[16:19], v2, s[22:23]
    global_load_dwordx2 v[20:21], v2, s[22:23] offset:16
    global_load_dwordx2 v[22:23], v3, s[24:25]
    s_mov_b64 exec, -1
    v_mov_b32 v224, 0
    v_mov_b32 v225, 0
    v_mov_b32 v226, 0
    v_mov_b32 v227, 0
    v_mov_b32 v228, 0
    v_mov_b32 v229, 0
    v_mov_b32 v231, 0
    v_mov_b32 v230, -1
    v_and_b32 v232, 63, v252
    s_lshl_b32 s4, s17, 11
    s_add_u32 s4, s4, 41984
    v_lshl_add_u32 v232, v232, 4, s4
    v_add_u32 v235, 32768, v232
    v_lshlrev_b32 v233, 2, v252
    ds_write_b128 v232, v[228:231] offset:0
    ds_write_b128 v232, v[228:231] offset:16384
    ds_write_b128 v235, v[228:231] offset:0
    ds_write_b128 v235, v[228:231] offset:16384
    ds_write_b128 v235, v[228:231] offset:32768
    ds_write_b32 v233, v224 offset:37888
    v_lshlrev_b32 v4, 4, v4
    s_mov_b32 s18, 0x05040100
    s_mov_b32 s19, 0x07060302
    s_mov_b64 exec, s[46:47]
    s_waitcnt vmcnt(4)
    v_mul_u32_u24 v24, 429497, v8
    v_lshrrev_b32 v24, 24, v24
    v_lshlrev_b32 v68, 2, v24
    ds_add_rtn_u32 v28, v68, v5 offset:0
    v_mul_u32_u24 v25, 429497, v9
    v_lshrrev_b32 v25, 24, v25
    v_lshlrev_b32 v69, 2, v25
    ds_add_rtn_u32 v29, v69, v5 offset:0
    v_mul_u32_u24 v26, 429497, v10
    v_lshrrev_b32 v26, 24, v26
    v_lshlrev_b32 v70, 2, v26
    ds_add_rtn_u32 v30, v70, v5 offset:0
    v_mul_u32_u24 v27, 429497, v11
    v_lshrrev_b32 v27, 24, v27
    v_lshlrev_b32 v71, 2, v27
    ds_add_rtn_u32 v31, v71, v5 offset:0
    v_mul_u32_u24 v6, 625, v24
    v_add_u32 v6, 15, v6
    v_lshrrev_b32 v6, 4, v6
    v_sub_u32 v8, v8, v6
    v_mul_u32_u24 v6, 625, v25
    v_add_u32 v6, 15, v6
    v_lshrrev_b32 v6, 4, v6
    v_sub_u32 v9, v9, v6
    v_mul_u32_u24 v6, 625, v26
    v_add_u32 v6, 15, v6
    v_lshrrev_b32 v6, 4, v6
    v_sub_u32 v10, v10, v6
    v_mul_u32_u24 v6, 625, v27
    v_add_u32 v6, 15, v6
    v_lshrrev_b32 v6, 4, v6
    v_sub_u32 v11, v11, v6
    s_mov_b64 exec, -1
    s_waitcnt lgkmcnt(0)
    s_barrier
    ds_read_b128 v[52:55], v4 offset:0
    s_cmp_lg_u32 s17, 7
    s_cbranch_scc1 L1_nt
    global_load_dwordx2 v[74:75], v73, s[36:37] sc1
L1_nt:
    s_waitcnt lgkmcnt(0)
    v_add_u32 v57, v52, v53
    v_add_u32 v58, v57, v54
    v_add_u32 v59, v58, v55
    v_mov_b32 v60, v59
    s_nop 1
    v_add_u32_dpp v60, v60, v60 row_shr:1 row_mask:0xf bank_mask:0xf bound_ctrl:0
    s_nop 1
    v_add_u32_dpp v60, v60, v60 row_shr:2 row_mask:0xf bank_mask:0xf bound_ctrl:0
    s_nop 1
    v_add_u32_dpp v60, v60, v60 row_shr:4 row_mask:0xf bank_mask:0xf bound_ctrl:0
    s_nop 1
    v_add_u32_dpp v60, v60, v60 row_shr:8 row_mask:0xf bank_mask:0xf bound_ctrl:0
    s_nop 1
    v_add_u32_dpp v60, v60, v60 row_bcast:15 row_mask:0xa bank_mask:0xf
    s_nop 1
    v_add_u32_dpp v60, v60, v60 row_bcast:31 row_mask:0xc bank_mask:0xf
    v_sub_u32 v60, v60, v59
    v_add_u32 v61, v60, v52
    v_add_u32 v62, v60, v57
    v_add_u32 v63, v60, v58
    ds_write_b128 v4, v[60:63] offset:1024
    s_mov_b64 exec, s[46:47]
    ds_read_b32 v24, v68 offset:1024
    ds_read_b32 v25, v69 offset:1024
    ds_read_b32 v26, v70 offset:1024
    ds_read_b32 v27, v71 offset:1024
    s_mov_b64 exec, -1
    s_cmp_eq_u32 s17, 7
    s_cbranch_scc1 L1_w1
    s_waitcnt vmcnt(0)
L1_w1:
    s_waitcnt vmcnt(1)
    s_cmp_eq_u32 s17, 3
    s_cselect_b32 s59, s2, 160
    s_min_u32 s59, s59, 160
    s_cmp_ge_u32 s59, 160
    s_cbranch_scc1 L1_b
    s_mul_i32 s4, s2, 1639
    s_lshr_b32 s4, s4, 16
    s_mul_i32 s5, s4, 40
    s_sub_u32 s5, s2, s5
    s_and_b32 s6, s5, 1
    s_lshr_b32 s5, s5, 1
    s_cmp_lt_u32 s5, 8
    s_cselect_b64 s[40:41], s[32:33], s[34:35]
    s_cselect_b32 s42, 0, 8
    s_sub_u32 s42, s5, s42
    s_lshl_b32 s42, s42, 13
    s_lshl_b32 s4, s4, 6
    s_add_u32 s42, s42, s4
    s_lshl_b32 s6, s6, 3
    s_add_u32 s42, s42, s6
    v_lshrrev_b32 v80, 8, v4
    v_bfe_u32 v81, v4, 6, 2
    v_bfe_u32 v82, v4, 4, 2
    v_lshlrev_b32 v83, 11, v80
    v_lshl_add_u32 v83, v81, 4, v83
    v_lshl_add_u32 v83, v82, 1, v83
    v_add_u32 v83, s42, v83
    s_lshl_b32 s5, s5, 6
    v_lshl_add_u32 v80, v80, 4, s5
    global_load_dwordx4 v[240:243], v80, s[30:31]
    global_load_ushort v232, v83, s[40:41] offset:0
    global_load_ushort v233, v83, s[40:41] offset:256
    global_load_ushort v234, v83, s[40:41] offset:512
    global_load_ushort v235, v83, s[40:41] offset:768
    global_load_ushort v236, v83, s[40:41] offset:1024
    global_load_ushort v237, v83, s[40:41] offset:1280
    global_load_ushort v238, v83, s[40:41] offset:1536
    global_load_ushort v239, v83, s[40:41] offset:1792
L1_b:
    s_mov_b64 exec, s[46:47]
    global_load_dword v223, v72, s[20:21]
    v_mad_u32_u24 v6, v12, s7, v66
    v_mul_u32_u24 v7, 13421773, v8
    v_and_b32 v7, 0x3ffffff, v7
    v_sub_u32 v6, v6, v7
    v_ashrrev_i32 v6, 26, v6
    v_med3_i32 v6, v6, 0, 6
    v_lshl_add_u32 v6, v8, 3, v6
    v_lshl_add_u32 v6, v12, 9, v6
    v_lshlrev_b32 v34, 2, v6
    v_lshlrev_b32 v48, 16, v22
    v_lshlrev_b32 v49, 16, v16
    v_and_b32 v50, 0xffff0000, v16
    v_lshlrev_b32 v51, 16, v17
    v_mul_f32 v49, v48, v49
    v_mul_f32 v50, v48, v50
    v_mul_f32 v51, v48, v51
    v_cvt_pk_bf16_f32 v32, v48, v49
    v_cvt_pk_bf16_f32 v33, v50, v51
    s_waitcnt lgkmcnt(0)
    v_add_lshl_u32 v24, v24, v28, 4
    ds_write_b96 v24, v[32:34] offset:2048
    v_mad_u32_u24 v6, v13, s7, v66
    v_mul_u32_u24 v7, 13421773, v9
    v_and_b32 v7, 0x3ffffff, v7
    v_sub_u32 v6, v6, v7
    v_ashrrev_i32 v6, 26, v6
    v_med3_i32 v6, v6, 0, 6
    v_lshl_add_u32 v6, v9, 3, v6
    v_lshl_add_u32 v6, v13, 9, v6
    v_lshlrev_b32 v38, 2, v6
    v_and_b32 v48, 0xffff0000, v22
    v_and_b32 v49, 0xffff0000, v17
    v_lshlrev_b32 v50, 16, v18
    v_and_b32 v51, 0xffff0000, v18
    v_mul_f32 v49, v48, v49
    v_mul_f32 v50, v48, v50
    v_mul_f32 v51, v48, v51
    v_cvt_pk_bf16_f32 v36, v48, v49
    v_cvt_pk_bf16_f32 v37, v50, v51
    v_add_lshl_u32 v25, v25, v29, 4
    ds_write_b96 v25, v[36:38] offset:2048
    s_mov_b64 exec, -1
    s_cmp_lg_u32 s17, 7
    s_cbranch_scc1 L1_c
    s_mov_b32 s6, 1048576
    s_waitcnt vmcnt(1)
L1_npoll:
    v_readfirstlane_b32 s5, v75
    s_cmp_lg_u32 s5, 0
    s_cbranch_scc1 L1_non2
    global_load_dwordx2 v[74:75], v73, s[36:37] sc1
    s_sub_u32 s6, s6, 1
    s_waitcnt vmcnt(0)
    s_cbranch_scc0 L1_npoll
L1_non2:
    v_readfirstlane_b32 s4, v74
    s_and_b32 s5, s5, 0x3ff
    v_mov_b32 v74, s4
    v_mov_b32 v75, s5
    ds_write_b64 v73, v[74:75] offset:36928
    s_cmp_ge_u32 s2, 250
    s_cbranch_scc1 L1_c
    v_lshl_or_b32 v60, v52, 11, v60
    v_lshl_or_b32 v76, v75, 22, v60
    v_mov_b32 v77, v74
    v_lshl_or_b32 v61, v53, 11, v61
    v_lshl_or_b32 v78, v75, 22, v61
    v_mov_b32 v79, v74
    v_lshl_or_b32 v62, v54, 11, v62
    v_lshl_or_b32 v80, v75, 22, v62
    v_mov_b32 v81, v74
    v_lshl_or_b32 v63, v55, 11, v63
    v_lshl_or_b32 v82, v75, 22, v63
    v_mov_b32 v83, v74
    s_lshl_b32 s4, s2, 11
    s_add_u32 s4, s4, 6291456
    v_lshl_add_u32 v5, v4, 1, s4
    global_store_dwordx4 v5, v[76:79], s[38:39] sc1
    global_store_dwordx4 v5, v[80:83], s[38:39] offset:16 sc1
L1_c:
    s_mov_b64 exec, s[46:47]
    v_mad_u32_u24 v6, v14, s7, v66
    v_mul_u32_u24 v7, 13421773, v10
    v_and_b32 v7, 0x3ffffff, v7
    v_sub_u32 v6, v6, v7
    v_ashrrev_i32 v6, 26, v6
    v_med3_i32 v6, v6, 0, 6
    v_lshl_add_u32 v6, v10, 3, v6
    v_lshl_add_u32 v6, v14, 9, v6
    v_lshlrev_b32 v42, 2, v6
    v_lshlrev_b32 v48, 16, v23
    v_lshlrev_b32 v49, 16, v19
    v_and_b32 v50, 0xffff0000, v19
    v_lshlrev_b32 v51, 16, v20
    v_mul_f32 v49, v48, v49
    v_mul_f32 v50, v48, v50
    v_mul_f32 v51, v48, v51
    v_cvt_pk_bf16_f32 v40, v48, v49
    v_cvt_pk_bf16_f32 v41, v50, v51
    v_add_lshl_u32 v26, v26, v30, 4
    ds_write_b96 v26, v[40:42] offset:2048
    v_mad_u32_u24 v6, v15, s7, v66
    v_mul_u32_u24 v7, 13421773, v11
    v_and_b32 v7, 0x3ffffff, v7
    v_sub_u32 v6, v6, v7
    v_ashrrev_i32 v6, 26, v6
    v_med3_i32 v6, v6, 0, 6
    v_lshl_add_u32 v6, v11, 3, v6
    v_lshl_add_u32 v6, v15, 9, v6
    v_lshlrev_b32 v46, 2, v6
    v_and_b32 v48, 0xffff0000, v23
    v_and_b32 v49, 0xffff0000, v20
    v_lshlrev_b32 v50, 16, v21
    v_and_b32 v51, 0xffff0000, v21
    v_mul_f32 v49, v48, v49
    v_mul_f32 v50, v48, v50
    v_mul_f32 v51, v48, v51
    v_cvt_pk_bf16_f32 v44, v48, v49
    v_cvt_pk_bf16_f32 v45, v50, v51
    v_add_lshl_u32 v27, v27, v31, 4
    ds_write_b96 v27, v[44:46] offset:2048
    s_mov_b64 exec, -1
    v_lshlrev_b32 v6, 4, v0
    s_mul_i32 s4, s2, 20480
    s_add_u32 s40, s38, s4
    s_addc_u32 s41, s39, 0
    s_mov_b64 s[8:9], s[20:21]
    s_mov_b64 s[14:15], s[38:39]
    s_mov_b64 s[62:63], s[20:21]
    s_waitcnt lgkmcnt(0)
    s_barrier
    ds_read_b64 v[74:75], v73 offset:36928
    s_cmp_ge_u32 s17, 4
    s_cbranch_scc1 L1_d
    s_cmp_ge_u32 s2, 250
    s_cbranch_scc1 L1_d
    ds_read_b96 v[12:14], v6 offset:2048
    ds_read_b96 v[16:18], v6 offset:6144
    ds_read_b96 v[20:22], v6 offset:10240
    ds_read_b96 v[24:26], v6 offset:14336
    ds_read_b96 v[28:30], v6 offset:18432
    v_add_u32 v7, 8192, v6
    v_add_u32 v8, 16384, v6
    s_waitcnt lgkmcnt(4)
    v_mov_b32 v15, v74
    v_lshl_or_b32 v14, v75, 25, v14
    global_store_dwordx4 v6, v[12:15], s[40:41] offset:0 sc1
    s_waitcnt lgkmcnt(3)
    v_mov_b32 v19, v74
    v_lshl_or_b32 v18, v75, 25, v18
    global_store_dwordx4 v7, v[16:19], s[40:41] offset:-4096 sc1
    s_waitcnt lgkmcnt(2)
    v_mov_b32 v23, v74
    v_lshl_or_b32 v22, v75, 25, v22
    global_store_dwordx4 v7, v[20:23], s[40:41] offset:0 sc1
    s_waitcnt lgkmcnt(1)
    v_mov_b32 v27, v74
    v_lshl_or_b32 v26, v75, 25, v26
    global_store_dwordx4 v8, v[24:27], s[40:41] offset:-4096 sc1
    s_waitcnt lgkmcnt(0)
    v_mov_b32 v31, v74
    v_lshl_or_b32 v30, v75, 25, v30
    global_store_dwordx4 v8, v[28:31], s[40:41] offset:0 sc1
L1_d:
    s_waitcnt lgkmcnt(0)
    v_readfirstlane_b32 s56, v74
    v_readfirstlane_b32 s58, v75
    v_add_u32 v222, 5120000, v72
    s_lshl_b32 s57, s58, 25
    v_lshrrev_b32 v211, 1, v252
    v_lshlrev_b32 v215, 2, v211
    v_and_b32 v214, 1, v252
    v_mul_u32_u24 v211, 1280, v211
    s_or_b32 s9, s9, 0x00100000
    s_mov_b32 s10, 10240000
    s_mov_b32 s11, 0x00800000
    s_add_u32 s40, s14, 4096
    s_addc_u32 s41, s15, 0
    v_mov_b32 v249, 0
    s_cmp_ge_u32 s17, 4
    s_cbranch_scc1 L1_p
    s_nop 4
    v_mfma_f32_32x32x16_bf16 v[144:159], v[224:227], v[224:227], 0
    v_mfma_f32_32x32x16_bf16 v[128:143], v[224:227], v[224:227], 0
    v_mfma_f32_32x32x16_bf16 v[112:127], v[224:227], v[224:227], 0
    v_mfma_f32_32x32x16_bf16 v[96:111], v[224:227], v[224:227], 0
    v_mfma_f32_32x32x16_bf16 v[80:95], v[224:227], v[224:227], 0
    v_mfma_f32_32x32x16_bf16 v[64:79], v[224:227], v[224:227], 0
    v_mfma_f32_32x32x16_bf16 v[48:63], v[224:227], v[224:227], 0
    v_mfma_f32_32x32x16_bf16 v[32:47], v[224:227], v[224:227], 0
    v_mfma_f32_32x32x16_bf16 v[16:31], v[224:227], v[224:227], 0
    v_mfma_f32_32x32x16_bf16 v[0:15], v[224:227], v[224:227], 0
    s_waitcnt vmcnt(0)
    s_branch L1_e
L1_p:
    v_add_u32 v210, -256, v252
    v_min_u32 v212, 249, v210
    s_lshl_b32 s4, s16, 3
    s_add_u32 s4, s4, 6291456
    v_lshl_add_u32 v212, v212, 11, s4
    s_mov_b32 s6, 1048576
    global_load_dwordx2 v[216:217], v212, s[14:15] sc1
    v_mfma_f32_32x32x16_bf16 v[144:159], v[224:227], v[224:227], 0
    v_mfma_f32_32x32x16_bf16 v[128:143], v[224:227], v[224:227], 0
    v_mfma_f32_32x32x16_bf16 v[112:127], v[224:227], v[224:227], 0
    v_mfma_f32_32x32x16_bf16 v[96:111], v[224:227], v[224:227], 0
    v_mfma_f32_32x32x16_bf16 v[80:95], v[224:227], v[224:227], 0
    v_mfma_f32_32x32x16_bf16 v[64:79], v[224:227], v[224:227], 0
    v_mfma_f32_32x32x16_bf16 v[48:63], v[224:227], v[224:227], 0
    v_mfma_f32_32x32x16_bf16 v[32:47], v[224:227], v[224:227], 0
    v_mfma_f32_32x32x16_bf16 v[16:31], v[224:227], v[224:227], 0
    v_mfma_f32_32x32x16_bf16 v[0:15], v[224:227], v[224:227], 0
    s_branch L2_poll1
L2_poll:
    global_load_dwordx2 v[216:217], v212, s[14:15] sc1
L2_poll1:
    s_waitcnt vmcnt(0)
    v_lshrrev_b32 v213, 22, v216
    v_cmp_ne_u32 vcc, s56, v217
    v_cmp_ne_u32 s[4:5], s58, v213
    s_or_b64 exec, vcc, s[4:5]
    s_cbranch_scc0 L2_got
    s_sub_u32 s6, s6, 1
    s_cbranch_scc0 L2_poll
    v_mov_b32 v216, 0
L2_got:
    s_mov_b64 exec, -1
    v_cmp_gt_u32 vcc, 250, v210
    v_lshlrev_b32 v210, 2, v210
    s_nop 0
    v_cndmask_b32 v216, 0, v216, vcc
    ds_write_b32 v210, v216 offset:25728
    v_bfe_u32 v213, v216, 11, 11
    v_and_b32 v217, 0x7ff, v216
    v_mov_b32 v218, v213
    v_mul_u32_u24 v210, 320, v210
    s_nop 1
    v_add_u32_dpp v218, v218, v218 row_shr:1 row_mask:0xf bank_mask:0xf bound_ctrl:0
    s_nop 1
    v_add_u32_dpp v218, v218, v218 row_shr:2 row_mask:0xf bank_mask:0xf bound_ctrl:0
    s_nop 1
    v_add_u32_dpp v218, v218, v218 row_shr:4 row_mask:0xf bank_mask:0xf bound_ctrl:0
    s_nop 1
    v_add_u32_dpp v218, v218, v218 row_shr:8 row_mask:0xf bank_mask:0xf bound_ctrl:0
    s_nop 1
    v_add_u32_dpp v218, v218, v218 row_bcast:15 row_mask:0xa bank_mask:0xf
    s_nop 1
    v_add_u32_dpp v218, v218, v218 row_bcast:31 row_mask:0xc bank_mask:0xf
    v_cmp_lt_u32 vcc, 24, v213
    v_add_u32 v217, v217, v210
    v_readlane_b32 s4, v218, 63
    v_sub_u32 v218, v218, v213
    v_sub_u32 v217, v217, v218
    s_lshl_b32 s5, s17, 11
    s_add_u32 s5, s5, 115712
    v_lshl_add_u32 v218, v218, 2, s5
    s_cmp_lg_u64 vcc, 0
    s_cselect_b32 s4, -1, s4
    s_lshl_b32 s5, s17, 2
    v_mov_b32 v219, s4
    v_mov_b32 v210, s5
    ds_write_b32 v210, v219 offset:36880
    s_cmp_gt_u32 s4, 512
    s_cbranch_scc1 L2_xd
    v_cmpx_lt_u32 vcc, 0, v213
    ds_write_b32 v218, v217 offset:0
    v_cmpx_lt_u32 vcc, 1, v213
    ds_write_b32 v218, v217 offset:4
    v_cmpx_lt_u32 vcc, 2, v213
    ds_write_b32 v218, v217 offset:8
    v_cmpx_lt_u32 vcc, 3, v213
    ds_write_b32 v218, v217 offset:12
    v_cmpx_lt_u32 vcc, 4, v213
    ds_write_b32 v218, v217 offset:16
    v_cmpx_lt_u32 vcc, 5, v213
    ds_write_b32 v218, v217 offset:20
    v_cmpx_lt_u32 vcc, 6, v213
    s_cbranch_execz L2_xd
    ds_write_b32 v218, v217 offset:24
    v_cmpx_lt_u32 vcc, 7, v213
    s_cbranch_execz L2_xd
    ds_write_b32 v218, v217 offset:28
    v_cmpx_lt_u32 vcc, 8, v213
    s_cbranch_execz L2_xd
    ds_write_b32 v218, v217 offset:32
    v_cmpx_lt_u32 vcc, 9, v213
    s_cbranch_execz L2_xd
    ds_write_b32 v218, v217 offset:36
    v_cmpx_lt_u32 vcc, 10, v213
    s_cbranch_execz L2_xd
    ds_write_b32 v218, v217 offset:40
    v_cmpx_lt_u32 vcc, 11, v213
    s_cbranch_execz L2_xd
    ds_write_b32 v218, v217 offset:44
    v_cmpx_lt_u32 vcc, 12, v213
    s_cbranch_execz L2_xd
    ds_write_b32 v218, v217 offset:48
    v_cmpx_lt_u32 vcc, 13, v213
    s_cbranch_execz L2_xd
    ds_write_b32 v218, v217 offset:52
    v_cmpx_lt_u32 vcc, 14, v213
    s_cbranch_execz L2_xd
    ds_write_b32 v218, v217 offset:56
    v_cmpx_lt_u32 vcc, 15, v213
    s_cbranch_execz L2_xd
    ds_write_b32 v218, v217 offset:60
    v_cmpx_lt_u32 vcc, 16, v213
    s_cbranch_execz L2_xd
    ds_write_b32 v218, v217 offset:64
    v_cmpx_lt_u32 vcc, 17, v213
    s_cbranch_execz L2_xd
    ds_write_b32 v218, v217 offset:68
    v_cmpx_lt_u32 vcc, 18, v213
    s_cbranch_execz L2_xd
    ds_write_b32 v218, v217 offset:72
    v_cmpx_lt_u32 vcc, 19, v213
    s_cbranch_execz L2_xd
    ds_write_b32 v218, v217 offset:76
    v_cmpx_lt_u32 vcc, 20, v213
    s_cbranch_execz L2_xd
    ds_write_b32 v218, v217 offset:80
    v_cmpx_lt_u32 vcc, 21, v213
    s_cbranch_execz L2_xd
    ds_write_b32 v218, v217 offset:84
    v_cmpx_lt_u32 vcc, 22, v213
    s_cbranch_execz L2_xd
    ds_write_b32 v218, v217 offset:88
    v_cmpx_lt_u32 vcc, 23, v213
    s_cbranch_execz L2_xd
    ds_write_b32 v218, v217 offset:92
L2_xd:
    s_mov_b64 exec, -1
    s_waitcnt lgkmcnt(0)
L1_e:
    v_and_b32 v212, 127, v252
    s_lshr_b32 s4, s17, 1
    s_lshl_b32 s5, s4, 11
    s_add_u32 s5, s5, 123904
    v_lshl_add_u32 v253, v212, 2, s5
    v_mov_b32 v210, 0
    s_barrier
    ds_read_b128 v[216:219], v210 offset:36896
    ds_read_b32 v200, v253 offset:0
    ds_read_b32 v201, v253 offset:512
    ds_read_b32 v202, v253 offset:1024
    ds_read_b32 v203, v253 offset:1536
    s_setprio 3
    s_mov_b32 s44, 0
    s_waitcnt lgkmcnt(4)
    v_max_u32 v213, v216, v217
    v_max3_u32 v213, v213, v218, v219
    s_cmp_eq_u32 s4, 1
    s_cselect_b64 vcc, -1, 0
    v_cndmask_b32 v216, v216, v217, vcc
    s_cmp_eq_u32 s4, 3
    s_cselect_b64 vcc, -1, 0
    v_cndmask_b32 v218, v218, v219, vcc
    v_readfirstlane_b32 s5, v213
    s_cmp_ge_u32 s4, 2
    s_cselect_b64 vcc, -1, 0
    v_cndmask_b32 v216, v216, v218, vcc
    s_cmp_gt_u32 s5, 512
    s_cbranch_scc1 L2_sparse
    s_mov_b32 s60, 1
    v_sub_u32 v216, v216, v212
    v_mov_b32 v250, 0
    s_waitcnt lgkmcnt(3)
    v_add_lshl_u32 v200, v200, v212, 4
    v_cmpx_lt_i32 s[20:21], 0, v216
    s_cbranch_execz L2_dk0
    global_load_dwordx4 v[160:163], v200, s[14:15] offset:0 sc1
L2_dk0:
    s_waitcnt lgkmcnt(2)
    v_add_lshl_u32 v201, v201, v212, 4
    s_movk_i32 s5, 128
    v_cmpx_lt_i32 s[22:23], s5, v216
    s_mov_b32 s42, 1
    s_cbranch_execz L2_ld
    global_load_dwordx4 v[164:167], v201, s[14:15] offset:2048 sc1
    s_waitcnt lgkmcnt(1)
    v_add_lshl_u32 v202, v202, v212, 4
    s_movk_i32 s5, 256
    v_cmpx_lt_i32 s[24:25], s5, v216
    s_mov_b32 s42, 2
    s_cbranch_execz L2_ld
    global_load_dwordx4 v[168:171], v202, s[40:41] offset:0 sc1
    s_waitcnt lgkmcnt(0)
    v_add_lshl_u32 v203, v203, v212, 4
    s_movk_i32 s5, 384
    v_cmpx_lt_i32 s[26:27], s5, v216
    s_mov_b32 s42, 3
    s_cbranch_execz L2_ld
    global_load_dwordx4 v[172:175], v203, s[40:41] offset:2048 sc1
    s_mov_b32 s42, 4
    s_branch L2_ld
L2_sparse:
    s_mov_b32 s60, 0
    ds_read_b32 v216, v215 offset:25728
    s_waitcnt lgkmcnt(0)
    v_and_b32 v212, 0x7ff, v216
    v_bfe_u32 v250, v216, 11, 11
    v_add3_u32 v211, v211, v212, v214
    v_sub_u32 v250, v250, v214
    v_lshlrev_b32 v249, 4, v211
L2_batch:
    v_cmpx_lt_i32 s[20:21], 0, v250
    global_load_dwordx4 v[160:163], v249, s[14:15] offset:0 sc1
    v_cmpx_lt_i32 s[22:23], 2, v250
    global_load_dwordx4 v[164:167], v249, s[14:15] offset:32 sc1
    v_cmpx_lt_i32 s[24:25], 4, v250
    s_mov_b32 s42, 2
    s_cbranch_execz L2_ld
    global_load_dwordx4 v[168:171], v249, s[14:15] offset:64 sc1
    v_cmpx_lt_i32 s[26:27], 6, v250
    s_mov_b32 s42, 3
    s_cbranch_execz L2_ld
    global_load_dwordx4 v[172:175], v249, s[14:15] offset:96 sc1
    v_cmpx_lt_i32 s[28:29], 8, v250
    s_mov_b32 s42, 4
    s_cbranch_execz L2_ld
    global_load_dwordx4 v[176:179], v249, s[14:15] offset:128 sc1
    v_cmpx_lt_i32 s[30:31], 10, v250
    s_mov_b32 s42, 5
    s_cbranch_execz L2_ld
    global_load_dwordx4 v[180:183], v249, s[14:15] offset:160 sc1
    v_cmpx_lt_i32 s[32:33], 12, v250
    s_mov_b32 s42, 6
    s_cbranch_execz L2_ld
    global_load_dwordx4 v[184:187], v249, s[14:15] offset:192 sc1
    v_cmpx_lt_i32 s[34:35], 14, v250
    s_mov_b32 s42, 7
    s_cbranch_execz L2_ld
    global_load_dwordx4 v[188:191], v249, s[14:15] offset:224 sc1
    v_cmpx_lt_i32 s[36:37], 16, v250
    s_mov_b32 s42, 8
    s_cbranch_execz L2_ld
    global_load_dwordx4 v[192:195], v249, s[14:15] offset:256 sc1
    v_cmpx_lt_i32 s[38:39], 18, v250
    s_mov_b32 s42, 9
    s_cbranch_execz L2_ld
    global_load_dwordx4 v[196:199], v249, s[14:15] offset:288 sc1
    s_mov_b32 s42, 10
L2_ld:
    s_mov_b64 exec, -1
    s_cmp_ge_u32 s59, 160
    s_cbranch_scc1 L2_nwp
    v_lshlrev_b32 v232, 16, v232
    v_lshlrev_b32 v247, 16, v240
    v_mul_f32 v232, v247, v232
    v_lshlrev_b32 v233, 16, v233
    v_and_b32 v247, 0xffff0000, v240
    v_mul_f32 v233, v247, v233
    v_lshlrev_b32 v234, 16, v234
    v_lshlrev_b32 v247, 16, v241
    v_mul_f32 v234, v247, v234
    v_lshlrev_b32 v235, 16, v235
    v_and_b32 v247, 0xffff0000, v241
    v_mul_f32 v235, v247, v235
    v_lshlrev_b32 v236, 16, v236
    v_lshlrev_b32 v247, 16, v242
    v_mul_f32 v236, v247, v236
    v_lshlrev_b32 v237, 16, v237
    v_and_b32 v247, 0xffff0000, v242
    v_mul_f32 v237, v247, v237
    v_lshlrev_b32 v238, 16, v238
    v_lshlrev_b32 v247, 16, v243
    v_mul_f32 v238, v247, v238
    v_lshlrev_b32 v239, 16, v239
    v_and_b32 v247, 0xffff0000, v243
    v_mul_f32 v239, v247, v239
    v_cvt_pk_bf16_f32 v240, v232, v233
    v_cvt_pk_bf16_f32 v241, v234, v235
    v_cvt_pk_bf16_f32 v242, v236, v237
    v_cvt_pk_bf16_f32 v243, v238, v239
L2_nwp:
    s_lshl_b32 s4, s59, 10
    s_add_u32 s4, s4, 7340032
    v_and_b32 v247, 63, v252
    v_lshl_add_u32 v247, v247, 4, s4
    v_mov_b32 v254, 64
    s_mov_b32 exec_lo, 0x200001
    s_mov_b32 exec_hi, 0x20000200
    v_mov_b32 v254, 0
    s_mov_b32 exec_lo, 0x20010
    s_mov_b32 exec_hi, 0x8004000
    v_mov_b32 v254, 16
    s_mov_b32 exec_lo, 0x80000100
    s_mov_b32 exec_hi, 0x400002
    v_mov_b32 v254, 32
    s_mov_b32 exec_lo, 0x4001000
    s_mov_b32 exec_hi, 0x20080
    v_mov_b32 v254, 48
    s_mov_b64 exec, -1
    v_and_b32 v244, 63, v252
    s_mul_i32 s4, s17, 10240
    s_add_u32 s4, s4, 41984
    v_lshl_add_u32 v255, v244, 4, s4
    v_lshlrev_b32 v244, 2, v244
    v_and_b32 v245, 28, v244
    s_mul_i32 s48, s17, 1280
    s_mul_i32 s49, s17, 3200
    v_add_u32 v244, s48, v244
    s_lshl_b32 s5, s17, 2
    v_mov_b32 v246, s5
    v_cmp_lt_i32 vcc, 20, v250
    s_cmp_lg_u64 vcc, 0
    s_cselect_b32 s43, 2, 0
    v_mov_b32 v211, 1
    v_and_b32 v210, 63, v252
    v_lshlrev_b32 v210, 5, v210
    v_mov_b32 v251, 0
    s_mov_b32 s6, 1048576
L2_chk:
    s_waitcnt vmcnt(0)
    v_mov_b32 v212, 0
    s_mov_b64 exec, s[20:21]
    v_xor_b32 v162, s57, v162
    v_xor_b32 v163, s56, v163
    v_lshrrev_b32 v213, 25, v162
    v_or3_b32 v212, v212, v213, v163
    s_mov_b64 exec, s[22:23]
    v_xor_b32 v166, s57, v166
    v_xor_b32 v167, s56, v167
    v_lshrrev_b32 v213, 25, v166
    v_or3_b32 v212, v212, v213, v167
    s_cmp_le_u32 s42, 2
    s_cbranch_scc1 L2_ck
    s_mov_b64 exec, s[24:25]
    v_xor_b32 v170, s57, v170
    v_xor_b32 v171, s56, v171
    v_lshrrev_b32 v213, 25, v170
    v_or3_b32 v212, v212, v213, v171
    s_cmp_le_u32 s42, 3
    s_cbranch_scc1 L2_ck
    s_mov_b64 exec, s[26:27]
    v_xor_b32 v174, s57, v174
    v_xor_b32 v175, s56, v175
    v_lshrrev_b32 v213, 25, v174
    v_or3_b32 v212, v212, v213, v175
    s_cmp_le_u32 s42, 4
    s_cbranch_scc1 L2_ck
    s_mov_b64 exec, s[28:29]
    v_xor_b32 v178, s57, v178
    v_xor_b32 v179, s56, v179
    v_lshrrev_b32 v213, 25, v178
    v_or3_b32 v212, v212, v213, v179
    s_cmp_le_u32 s42, 5
    s_cbranch_scc1 L2_ck
    s_mov_b64 exec, s[30:31]
    v_xor_b32 v182, s57, v182
    v_xor_b32 v183, s56, v183
    v_lshrrev_b32 v213, 25, v182
    v_or3_b32 v212, v212, v213, v183
    s_cmp_le_u32 s42, 6
    s_cbranch_scc1 L2_ck
    s_mov_b64 exec, s[32:33]
    v_xor_b32 v186, s57, v186
    v_xor_b32 v187, s56, v187
    v_lshrrev_b32 v213, 25, v186
    v_or3_b32 v212, v212, v213, v187
    s_cmp_le_u32 s42, 7
    s_cbranch_scc1 L2_ck
    s_mov_b64 exec, s[34:35]
    v_xor_b32 v190, s57, v190
    v_xor_b32 v191, s56, v191
    v_lshrrev_b32 v213, 25, v190
    v_or3_b32 v212, v212, v213, v191
    s_cmp_le_u32 s42, 8
    s_cbranch_scc1 L2_ck
    s_mov_b64 exec, s[36:37]
    v_xor_b32 v194, s57, v194
    v_xor_b32 v195, s56, v195
    v_lshrrev_b32 v213, 25, v194
    v_or3_b32 v212, v212, v213, v195
    s_cmp_le_u32 s42, 9
    s_cbranch_scc1 L2_ck
    s_mov_b64 exec, s[38:39]
    v_xor_b32 v198, s57, v198
    v_xor_b32 v199, s56, v199
    v_lshrrev_b32 v213, 25, v198
    v_or3_b32 v212, v212, v213, v199
L2_ck:
    s_mov_b64 exec, -1
    v_cmp_ne_u32 vcc, 0, v212
    s_cmp_eq_u64 vcc, 0
    s_cbranch_scc1 L2_ok
    s_sub_u32 s6, s6, 1
    s_cbranch_scc1 L2_end
    s_cmp_eq_u32 s60, 1
    s_cbranch_scc1 L2_rld
    s_mov_b64 exec, s[20:21]
    global_load_dwordx4 v[160:163], v249, s[14:15] offset:0 sc1
    s_mov_b64 exec, s[22:23]
    global_load_dwordx4 v[164:167], v249, s[14:15] offset:32 sc1
    s_cmp_le_u32 s42, 2
    s_cbranch_scc1 L2_rl
    s_mov_b64 exec, s[24:25]
    global_load_dwordx4 v[168:171], v249, s[14:15] offset:64 sc1
    s_cmp_le_u32 s42, 3
    s_cbranch_scc1 L2_rl
    s_mov_b64 exec, s[26:27]
    global_load_dwordx4 v[172:175], v249, s[14:15] offset:96 sc1
    s_cmp_le_u32 s42, 4
    s_cbranch_scc1 L2_rl
    s_mov_b64 exec, s[28:29]
    global_load_dwordx4 v[176:179], v249, s[14:15] offset:128 sc1
    s_cmp_le_u32 s42, 5
    s_cbranch_scc1 L2_rl
    s_mov_b64 exec, s[30:31]
    global_load_dwordx4 v[180:183], v249, s[14:15] offset:160 sc1
    s_cmp_le_u32 s42, 6
    s_cbranch_scc1 L2_rl
    s_mov_b64 exec, s[32:33]
    global_load_dwordx4 v[184:187], v249, s[14:15] offset:192 sc1
    s_cmp_le_u32 s42, 7
    s_cbranch_scc1 L2_rl
    s_mov_b64 exec, s[34:35]
    global_load_dwordx4 v[188:191], v249, s[14:15] offset:224 sc1
    s_cmp_le_u32 s42, 8
    s_cbranch_scc1 L2_rl
    s_mov_b64 exec, s[36:37]
    global_load_dwordx4 v[192:195], v249, s[14:15] offset:256 sc1
    s_cmp_le_u32 s42, 9
    s_cbranch_scc1 L2_rl
    s_mov_b64 exec, s[38:39]
    global_load_dwordx4 v[196:199], v249, s[14:15] offset:288 sc1
L2_rl:
    s_mov_b64 exec, -1
    s_branch L2_chk
L2_rld:
    s_cmp_le_u32 s42, 0
    s_cbranch_scc1 L2_rk3
    s_mov_b64 exec, s[20:21]
    s_cbranch_execz L2_rk0
    global_load_dwordx4 v[160:163], v200, s[14:15] offset:0 sc1
L2_rk0:
    s_cmp_le_u32 s42, 1
    s_cbranch_scc1 L2_rk3
    s_mov_b64 exec, s[22:23]
    s_cbranch_execz L2_rk1
    global_load_dwordx4 v[164:167], v201, s[14:15] offset:2048 sc1
L2_rk1:
    s_cmp_le_u32 s42, 2
    s_cbranch_scc1 L2_rk3
    s_mov_b64 exec, s[24:25]
    s_cbranch_execz L2_rk2
    global_load_dwordx4 v[168:171], v202, s[40:41] offset:0 sc1
L2_rk2:
    s_cmp_le_u32 s42, 3
    s_cbranch_scc1 L2_rk3
    s_mov_b64 exec, s[26:27]
    s_cbranch_execz L2_rk3
    global_load_dwordx4 v[172:175], v203, s[40:41] offset:2048 sc1
L2_rk3:
    s_mov_b64 exec, -1
    s_branch L2_chk
L2_ok:
    s_mov_b64 exec, s[20:21]
    v_and_b32 v200, 0x7fc, v162
    ds_add_rtn_u32 v163, v200, v211 offset:37888
    s_mov_b64 exec, s[22:23]
    v_and_b32 v201, 0x7fc, v166
    ds_add_rtn_u32 v167, v201, v211 offset:37888
    s_cmp_le_u32 s42, 2
    s_cbranch_scc1 L2_at
    s_mov_b64 exec, s[24:25]
    v_and_b32 v202, 0x7fc, v170
    ds_add_rtn_u32 v171, v202, v211 offset:37888
    s_cmp_le_u32 s42, 3
    s_cbranch_scc1 L2_at
    s_mov_b64 exec, s[26:27]
    v_and_b32 v203, 0x7fc, v174
    ds_add_rtn_u32 v175, v203, v211 offset:37888
    s_cmp_le_u32 s42, 4
    s_cbranch_scc1 L2_at
    s_mov_b64 exec, s[28:29]
    v_and_b32 v204, 0x7fc, v178
    ds_add_rtn_u32 v179, v204, v211 offset:37888
    s_cmp_le_u32 s42, 5
    s_cbranch_scc1 L2_at
    s_mov_b64 exec, s[30:31]
    v_and_b32 v205, 0x7fc, v182
    ds_add_rtn_u32 v183, v205, v211 offset:37888
    s_cmp_le_u32 s42, 6
    s_cbranch_scc1 L2_at
    s_mov_b64 exec, s[32:33]
    v_and_b32 v206, 0x7fc, v186
    ds_add_rtn_u32 v187, v206, v211 offset:37888
    s_cmp_le_u32 s42, 7
    s_cbranch_scc1 L2_at
    s_mov_b64 exec, s[34:35]
    v_and_b32 v207, 0x7fc, v190
    ds_add_rtn_u32 v191, v207, v211 offset:37888
    s_cmp_le_u32 s42, 8
    s_cbranch_scc1 L2_at
    s_mov_b64 exec, s[36:37]
    v_and_b32 v208, 0x7fc, v194
    ds_add_rtn_u32 v195, v208, v211 offset:37888
    s_cmp_le_u32 s42, 9
    s_cbranch_scc1 L2_at
    s_mov_b64 exec, s[38:39]
    v_and_b32 v209, 0x7fc, v198
    ds_add_rtn_u32 v199, v209, v211 offset:37888
L2_at:
    s_mov_b64 exec, s[46:47]
    s_cmp_gt_u32 s59, 160
    s_cbranch_scc1 L2_nf
    global_load_dword v223, v222, s[62:63]
    s_cmp_eq_u32 s59, 160
    s_cbranch_scc1 L2_nf
    s_mov_b64 exec, -1
    global_store_dwordx4 v247, v[240:243], s[14:15] sc1
    s_mov_b64 exec, s[46:47]
L2_nf:
    s_waitcnt lgkmcnt(0)
    s_barrier
    ds_read_b128 v[212:215], v210 offset:37888
    ds_read_b128 v[216:219], v210 offset:37904
    s_waitcnt lgkmcnt(0)
    v_add3_u32 v220, v212, v213, v214
    v_add3_u32 v220, v220, v215, v216
    v_add3_u32 v220, v220, v217, v218
    v_sub_u32 v220, 64, v220
    v_max_i32 v220, 0, v220
    v_and_b32 v221, -8, v220
    v_min_u32 v224, 8, v221
    v_add_u32 v220, v220, v212
    v_add_u32 v222, v224, v212
    v_and_b32 v221, -8, v220
    v_min_u32 v221, 16, v221
    v_max_u32 v225, v221, v222
    v_add_u32 v220, v220, v213
    v_add_u32 v222, v225, v213
    v_and_b32 v221, -8, v220
    v_min_u32 v221, 24, v221
    v_max_u32 v226, v221, v222
    v_add_u32 v220, v220, v214
    v_add_u32 v222, v226, v214
    v_and_b32 v221, -8, v220
    v_min_u32 v221, 32, v221
    v_max_u32 v227, v221, v222
    v_add_u32 v220, v220, v215
    v_add_u32 v222, v227, v215
    v_and_b32 v221, -8, v220
    v_min_u32 v221, 40, v221
    v_max_u32 v228, v221, v222
    v_add_u32 v220, v220, v216
    v_add_u32 v222, v228, v216
    v_and_b32 v221, -8, v220
    v_min_u32 v221, 48, v221
    v_max_u32 v229, v221, v222
    v_add_u32 v220, v220, v217
    v_add_u32 v222, v229, v217
    v_and_b32 v221, -8, v220
    v_min_u32 v221, 56, v221
    v_max_u32 v230, v221, v222
    ds_write_b128 v210, v[224:227] offset:39936
    ds_write_b128 v210, v[228:231] offset:39952
    s_mov_b64 exec, s[20:21]
    ds_read_b32 v232, v200 offset:39936
    v_and_b32 v200, 0x7e0, v200
    v_lshlrev_b32 v200, 6, v200
    s_mov_b64 exec, s[22:23]
    ds_read_b32 v233, v201 offset:39936
    v_and_b32 v201, 0x7e0, v201
    v_lshlrev_b32 v201, 6, v201
    s_cmp_le_u32 s42, 2
    s_cbranch_scc1 L2_st
    s_mov_b64 exec, s[24:25]
    ds_read_b32 v234, v202 offset:39936
    v_and_b32 v202, 0x7e0, v202
    v_lshlrev_b32 v202, 6, v202
    s_cmp_le_u32 s42, 3
    s_cbranch_scc1 L2_st
    s_mov_b64 exec, s[26:27]
    ds_read_b32 v235, v203 offset:39936
    v_and_b32 v203, 0x7e0, v203
    v_lshlrev_b32 v203, 6, v203
    s_cmp_le_u32 s42, 4
    s_cbranch_scc1 L2_st
    s_mov_b64 exec, s[28:29]
    ds_read_b32 v236, v204 offset:39936
    v_and_b32 v204, 0x7e0, v204
    v_lshlrev_b32 v204, 6, v204
    s_cmp_le_u32 s42, 5
    s_cbranch_scc1 L2_st
    s_mov_b64 exec, s[30:31]
    ds_read_b32 v237, v205 offset:39936
    v_and_b32 v205, 0x7e0, v205
    v_lshlrev_b32 v205, 6, v205
    s_cmp_le_u32 s42, 6
    s_cbranch_scc1 L2_st
    s_mov_b64 exec, s[32:33]
    ds_read_b32 v238, v206 offset:39936
    v_and_b32 v206, 0x7e0, v206
    v_lshlrev_b32 v206, 6, v206
    s_cmp_le_u32 s42, 7
    s_cbranch_scc1 L2_st
    s_mov_b64 exec, s[34:35]
    ds_read_b32 v239, v207 offset:39936
    v_and_b32 v207, 0x7e0, v207
    v_lshlrev_b32 v207, 6, v207
    s_cmp_le_u32 s42, 8
    s_cbranch_scc1 L2_st
    s_mov_b64 exec, s[36:37]
    ds_read_b32 v240, v208 offset:39936
    v_and_b32 v208, 0x7e0, v208
    v_lshlrev_b32 v208, 6, v208
    s_cmp_le_u32 s42, 9
    s_cbranch_scc1 L2_st
    s_mov_b64 exec, s[38:39]
    ds_read_b32 v241, v209 offset:39936
    v_and_b32 v209, 0x7e0, v209
    v_lshlrev_b32 v209, 6, v209
L2_st:
    s_waitcnt lgkmcnt(0)
    s_mov_b64 exec, s[20:21]
    v_add_u32 v232, v232, v163
    v_min_u32 v232, 64, v232
    v_lshl_add_u32 v200, v232, 4, v200
    v_lshrrev_b32 v232, 6, v232
    ds_write_b96 v200, v[160:162] offset:41984
    v_lshl_or_b32 v251, v232, 0, v251
    s_mov_b64 exec, s[22:23]
    v_add_u32 v233, v233, v167
    v_min_u32 v233, 64, v233
    v_lshl_add_u32 v201, v233, 4, v201
    v_lshrrev_b32 v233, 6, v233
    ds_write_b96 v201, v[164:166] offset:41984
    v_lshl_or_b32 v251, v233, 1, v251
    s_cmp_le_u32 s42, 2
    s_cbranch_scc1 L2_pl
    s_mov_b64 exec, s[24:25]
    v_add_u32 v234, v234, v171
    v_min_u32 v234, 64, v234
    v_lshl_add_u32 v202, v234, 4, v202
    v_lshrrev_b32 v234, 6, v234
    ds_write_b96 v202, v[168:170] offset:41984
    v_lshl_or_b32 v251, v234, 2, v251
    s_cmp_le_u32 s42, 3
    s_cbranch_scc1 L2_pl
    s_mov_b64 exec, s[26:27]
    v_add_u32 v235, v235, v175
    v_min_u32 v235, 64, v235
    v_lshl_add_u32 v203, v235, 4, v203
    v_lshrrev_b32 v235, 6, v235
    ds_write_b96 v203, v[172:174] offset:41984
    v_lshl_or_b32 v251, v235, 3, v251
    s_cmp_le_u32 s42, 4
    s_cbranch_scc1 L2_pl
    s_mov_b64 exec, s[28:29]
    v_add_u32 v236, v236, v179
    v_min_u32 v236, 64, v236
    v_lshl_add_u32 v204, v236, 4, v204
    v_lshrrev_b32 v236, 6, v236
    ds_write_b96 v204, v[176:178] offset:41984
    v_lshl_or_b32 v251, v236, 4, v251
    s_cmp_le_u32 s42, 5
    s_cbranch_scc1 L2_pl
    s_mov_b64 exec, s[30:31]
    v_add_u32 v237, v237, v183
    v_min_u32 v237, 64, v237
    v_lshl_add_u32 v205, v237, 4, v205
    v_lshrrev_b32 v237, 6, v237
    ds_write_b96 v205, v[180:182] offset:41984
    v_lshl_or_b32 v251, v237, 5, v251
    s_cmp_le_u32 s42, 6
    s_cbranch_scc1 L2_pl
    s_mov_b64 exec, s[32:33]
    v_add_u32 v238, v238, v187
    v_min_u32 v238, 64, v238
    v_lshl_add_u32 v206, v238, 4, v206
    v_lshrrev_b32 v238, 6, v238
    ds_write_b96 v206, v[184:186] offset:41984
    v_lshl_or_b32 v251, v238, 6, v251
    s_cmp_le_u32 s42, 7
    s_cbranch_scc1 L2_pl
    s_mov_b64 exec, s[34:35]
    v_add_u32 v239, v239, v191
    v_min_u32 v239, 64, v239
    v_lshl_add_u32 v207, v239, 4, v207
    v_lshrrev_b32 v239, 6, v239
    ds_write_b96 v207, v[188:190] offset:41984
    v_lshl_or_b32 v251, v239, 7, v251
    s_cmp_le_u32 s42, 8
    s_cbranch_scc1 L2_pl
    s_mov_b64 exec, s[36:37]
    v_add_u32 v240, v240, v195
    v_min_u32 v240, 64, v240
    v_lshl_add_u32 v208, v240, 4, v208
    v_lshrrev_b32 v240, 6, v240
    ds_write_b96 v208, v[192:194] offset:41984
    v_lshl_or_b32 v251, v240, 8, v251
    s_cmp_le_u32 s42, 9
    s_cbranch_scc1 L2_pl
    s_mov_b64 exec, s[38:39]
    v_add_u32 v241, v241, v199
    v_min_u32 v241, 64, v241
    v_lshl_add_u32 v209, v241, 4, v209
    v_lshrrev_b32 v241, 6, v241
    ds_write_b96 v209, v[196:198] offset:41984
    v_lshl_or_b32 v251, v241, 9, v251
L2_pl:
    s_mov_b64 exec, -1
    v_cmp_ne_u32 vcc, 0, v251
    s_cmp_lg_u64 vcc, 0
    s_addc_u32 s4, s43, 0
    v_mov_b32 v212, s4
    ds_write_b32 v246, v212 offset:36864
    s_waitcnt lgkmcnt(0)
    s_barrier
    ds_read_b32 v232, v255 offset:8
    ds_read_b32 v233, v255 offset:2056
    ds_read_b32 v234, v255 offset:4104
    ds_read_b32 v235, v255 offset:6152
    ds_read_b32 v236, v255 offset:8200
    ds_read_b32 v238, v245 offset:36864
    v_mov_b64 v[160:161], 0
    v_mov_b64 v[162:163], 0
    v_mov_b64 v[164:165], 0
    v_mov_b64 v[166:167], 0
    v_mov_b64 v[168:169], 0
    v_mov_b64 v[170:171], 0
    v_mov_b64 v[172:173], 0
    v_mov_b64 v[174:175], 0
    v_mov_b64 v[176:177], 0
    v_mov_b64 v[178:179], 0
    v_mov_b64 v[180:181], 0
    v_mov_b64 v[182:183], 0
    v_mov_b64 v[184:185], 0
    v_mov_b64 v[186:187], 0
    v_mov_b64 v[188:189], 0
    v_mov_b64 v[190:191], 0
    s_waitcnt lgkmcnt(5)
    v_lshrrev_b32 v232, 11, v232
    v_lshlrev_b32 v232, 10, v232
    v_cmp_gt_u32 s[28:29], s10, v232
    ds_write_b32 v244, v232 offset:25728
    s_waitcnt lgkmcnt(5)
    v_lshrrev_b32 v233, 11, v233
    v_lshlrev_b32 v233, 10, v233
    v_cmp_gt_u32 s[30:31], s10, v233
    ds_write_b32 v244, v233 offset:25984
    s_waitcnt lgkmcnt(5)
    v_lshrrev_b32 v234, 11, v234
    v_lshlrev_b32 v234, 10, v234
    v_cmp_gt_u32 s[32:33], s10, v234
    ds_write_b32 v244, v234 offset:26240
    s_waitcnt lgkmcnt(5)
    v_lshrrev_b32 v235, 11, v235
    v_lshlrev_b32 v235, 10, v235
    v_cmp_gt_u32 s[34:35], s10, v235
    ds_write_b32 v244, v235 offset:26496
    s_waitcnt lgkmcnt(5)
    v_lshrrev_b32 v236, 11, v236
    v_lshlrev_b32 v236, 10, v236
    v_cmp_gt_u32 s[36:37], s10, v236
    ds_write_b32 v244, v236 offset:26752
    s_or_b64 s[4:5], s[28:29], s[30:31]
    s_or_b64 s[4:5], s[4:5], s[32:33]
    s_or_b64 s[4:5], s[4:5], s[34:35]
    s_or_b64 s[4:5], s[4:5], s[36:37]
    s_bitset1_b32 s5, 24
    s_ff1_i32_b64 s6, s[4:5]
    s_and_b32 s6, s6, 0x38
    s_lshr_b64 s[28:29], s[28:29], s6
    s_lshr_b64 s[30:31], s[30:31], s6
    s_lshr_b64 s[32:33], s[32:33], s6
    s_lshr_b64 s[34:35], s[34:35], s6
    s_lshr_b64 s[36:37], s[36:37], s6
    s_lshl_b32 s7, s6, 2
    s_add_u32 s7, s7, s48
    v_mov_b32 v253, s7
    s_mul_i32 s7, s6, 10
    s_add_u32 s7, s7, s49
    v_add_u32 v248, s7, v254
    s_lshr_b32 s6, s6, 3
    s_sub_u32 s40, 8, s6
    s_and_b32 s51, s6, 1
    s_cmp_lt_u32 s17, 4
    s_cselect_b32 s41, 1, 0
    s_add_u32 s41, s41, s6
    ds_read_b128 v[240:243], v253 offset:25728
    ds_read_b128 v[244:247], v253 offset:25744
    v_mov_b64 v[192:193], 0
    v_mov_b64 v[194:195], 0
    v_mov_b64 v[196:197], 0
    v_mov_b64 v[198:199], 0
    v_mov_b64 v[200:201], 0
    v_mov_b64 v[202:203], 0
    v_mov_b64 v[204:205], 0
    v_mov_b64 v[206:207], 0
    v_mov_b64 v[208:209], 0
    v_mov_b64 v[210:211], 0
    v_mov_b64 v[212:213], 0
    v_mov_b64 v[214:215], 0
    v_mov_b64 v[216:217], 0
    v_mov_b64 v[218:219], 0
    v_mov_b64 v[220:221], 0
    v_mov_b64 v[222:223], 0
    s_and_b32 s38, s28, 0xff
    s_bcnt1_i32_b32 s38, s38
    s_lshr_b64 s[28:29], s[28:29], 8
    s_and_b32 s39, s30, 0xff
    s_bcnt1_i32_b32 s39, s39
    s_lshr_b64 s[30:31], s[30:31], 8
    s_mov_b32 s43, s39
    s_cmp_eq_u32 s51, 1
    s_cselect_b32 s39, s38, s39
    s_cselect_b32 s38, s43, s38
    s_waitcnt lgkmcnt(0)
    s_cmp_eq_u32 s51, 1
    s_cbranch_scc1 L2_o0
    s_cmp_le_u32 s38, 0
    s_cbranch_scc1 L2_w0_8
    buffer_load_dwordx4 v[160:163], v240, s[8:11], 0 offen
    s_cmp_le_u32 s38, 1
    s_cbranch_scc1 L2_w0_8
    buffer_load_dwordx4 v[164:167], v241, s[8:11], 0 offen
    s_cmp_le_u32 s38, 2
    s_cbranch_scc1 L2_w0_8
    buffer_load_dwordx4 v[168:171], v242, s[8:11], 0 offen
    s_cmp_le_u32 s38, 3
    s_cbranch_scc1 L2_w0_8
    buffer_load_dwordx4 v[172:175], v243, s[8:11], 0 offen
    s_cmp_le_u32 s38, 4
    s_cbranch_scc1 L2_w0_8
    buffer_load_dwordx4 v[176:179], v244, s[8:11], 0 offen
    s_cmp_le_u32 s38, 5
    s_cbranch_scc1 L2_w0_8
    buffer_load_dwordx4 v[180:183], v245, s[8:11], 0 offen
    s_cmp_le_u32 s38, 6
    s_cbranch_scc1 L2_w0_8
    buffer_load_dwordx4 v[184:187], v246, s[8:11], 0 offen
    s_cmp_le_u32 s38, 7
    s_cbranch_scc1 L2_w0_8
    buffer_load_dwordx4 v[188:191], v247, s[8:11], 0 offen
L2_w0_8:
    s_branch L2_oe0
L2_o0:
    s_cmp_le_u32 s39, 0
    s_cbranch_scc1 L2_w1_8
    buffer_load_dwordx4 v[192:195], v240, s[8:11], 0 offen
    s_cmp_le_u32 s39, 1
    s_cbranch_scc1 L2_w1_8
    buffer_load_dwordx4 v[196:199], v241, s[8:11], 0 offen
    s_cmp_le_u32 s39, 2
    s_cbranch_scc1 L2_w1_8
    buffer_load_dwordx4 v[200:203], v242, s[8:11], 0 offen
    s_cmp_le_u32 s39, 3
    s_cbranch_scc1 L2_w1_8
    buffer_load_dwordx4 v[204:207], v243, s[8:11], 0 offen
    s_cmp_le_u32 s39, 4
    s_cbranch_scc1 L2_w1_8
    buffer_load_dwordx4 v[208:211], v244, s[8:11], 0 offen
    s_cmp_le_u32 s39, 5
    s_cbranch_scc1 L2_w1_8
    buffer_load_dwordx4 v[212:215], v245, s[8:11], 0 offen
    s_cmp_le_u32 s39, 6
    s_cbranch_scc1 L2_w1_8
    buffer_load_dwordx4 v[216:219], v246, s[8:11], 0 offen
    s_cmp_le_u32 s39, 7
    s_cbranch_scc1 L2_w1_8
    buffer_load_dwordx4 v[220:223], v247, s[8:11], 0 offen
L2_w1_8:
L2_oe0:
    ds_read_b128 v[240:243], v253 offset:25984
    ds_read_b128 v[244:247], v253 offset:26000
    v_and_b32 v239, 1, v238
    v_cmp_ne_u32 vcc, 0, v239
    s_or_b32 s44, vcc_lo, vcc_hi
    v_cmp_lt_u32 vcc, 1, v238
    s_or_b32 s45, vcc_lo, vcc_hi
    s_or_b32 s50, s44, s45
    s_cselect_b32 s50, -1, 1
    ds_read_b64 v[224:225], v255 offset:0
    ds_read_b64 v[226:227], v255 offset:2048
    ds_read_b64 v[228:229], v255 offset:4096
    ds_read_b64 v[230:231], v255 offset:6144
    ds_read_b64 v[232:233], v255 offset:8192
    v_mov_b32 v234, s18
    v_mov_b32 v235, s19
    v_bfe_u32 v238, v252, 3, 3
    v_mul_u32_u24 v238, 80, v238
    v_bfe_u32 v236, v252, 1, 2
    v_lshl_add_u32 v238, v236, 2, v238
    v_add_u32 v238, s49, v238
    s_mov_b32 s6, 0xaaaaaaaa
    s_mov_b32 s7, 0xaaaaaaaa
    s_mov_b64 exec, s[6:7]
    v_mov_b32 v234, 0x01000504
    v_mov_b32 v235, 0x03020706
    v_add_u32 v238, 32, v238
    s_mov_b64 exec, -1
    s_waitcnt lgkmcnt(5)
    s_cmp_eq_u32 s51, 1
    s_cbranch_scc1 L2_o1
    s_cmp_le_u32 s39, 0
    s_cbranch_scc1 L2_w2_8
    buffer_load_dwordx4 v[192:195], v240, s[8:11], 0 offen
    s_cmp_le_u32 s39, 1
    s_cbranch_scc1 L2_w2_8
    buffer_load_dwordx4 v[196:199], v241, s[8:11], 0 offen
    s_cmp_le_u32 s39, 2
    s_cbranch_scc1 L2_w2_8
    buffer_load_dwordx4 v[200:203], v242, s[8:11], 0 offen
    s_cmp_le_u32 s39, 3
    s_cbranch_scc1 L2_w2_8
    buffer_load_dwordx4 v[204:207], v243, s[8:11], 0 offen
    s_cmp_le_u32 s39, 4
    s_cbranch_scc1 L2_w2_8
    buffer_load_dwordx4 v[208:211], v244, s[8:11], 0 offen
    s_cmp_le_u32 s39, 5
    s_cbranch_scc1 L2_w2_8
    buffer_load_dwordx4 v[212:215], v245, s[8:11], 0 offen
    s_cmp_le_u32 s39, 6
    s_cbranch_scc1 L2_w2_8
    buffer_load_dwordx4 v[216:219], v246, s[8:11], 0 offen
    s_cmp_le_u32 s39, 7
    s_cbranch_scc1 L2_w2_8
    buffer_load_dwordx4 v[220:223], v247, s[8:11], 0 offen
L2_w2_8:
    s_branch L2_oe1
L2_o1:
    s_cmp_le_u32 s38, 0
    s_cbranch_scc1 L2_w3_8
    buffer_load_dwordx4 v[160:163], v240, s[8:11], 0 offen
    s_cmp_le_u32 s38, 1
    s_cbranch_scc1 L2_w3_8
    buffer_load_dwordx4 v[164:167], v241, s[8:11], 0 offen
    s_cmp_le_u32 s38, 2
    s_cbranch_scc1 L2_w3_8
    buffer_load_dwordx4 v[168:171], v242, s[8:11], 0 offen
    s_cmp_le_u32 s38, 3
    s_cbranch_scc1 L2_w3_8
    buffer_load_dwordx4 v[172:175], v243, s[8:11], 0 offen
    s_cmp_le_u32 s38, 4
    s_cbranch_scc1 L2_w3_8
    buffer_load_dwordx4 v[176:179], v244, s[8:11], 0 offen
    s_cmp_le_u32 s38, 5
    s_cbranch_scc1 L2_w3_8
    buffer_load_dwordx4 v[180:183], v245, s[8:11], 0 offen
    s_cmp_le_u32 s38, 6
    s_cbranch_scc1 L2_w3_8
    buffer_load_dwordx4 v[184:187], v246, s[8:11], 0 offen
    s_cmp_le_u32 s38, 7
    s_cbranch_scc1 L2_w3_8
    buffer_load_dwordx4 v[188:191], v247, s[8:11], 0 offen
L2_w3_8:
L2_oe1:
    s_waitcnt lgkmcnt(0)
    v_cndmask_b32 v237, v225, v224, s[6:7]
    v_cndmask_b32 v236, v224, v225, s[6:7]
    s_nop 0
    v_mov_b32_dpp v239, v237 quad_perm:[1,0,3,2] row_mask:0xf bank_mask:0xf
    v_perm_b32 v224, v239, v236, v234
    v_perm_b32 v225, v239, v236, v235
    ds_write2_b32 v238, v224, v225 offset0:0 offset1:4
    v_add_u32 v238, 640, v238
    v_cndmask_b32 v237, v227, v226, s[6:7]
    v_cndmask_b32 v236, v226, v227, s[6:7]
    s_nop 0
    v_mov_b32_dpp v239, v237 quad_perm:[1,0,3,2] row_mask:0xf bank_mask:0xf
    v_perm_b32 v226, v239, v236, v234
    v_perm_b32 v227, v239, v236, v235
    ds_write2_b32 v238, v226, v227 offset0:0 offset1:4
    v_add_u32 v238, 640, v238
    v_cndmask_b32 v237, v229, v228, s[6:7]
    v_cndmask_b32 v236, v228, v229, s[6:7]
    s_nop 0
    v_mov_b32_dpp v239, v237 quad_perm:[1,0,3,2] row_mask:0xf bank_mask:0xf
    v_perm_b32 v228, v239, v236, v234
    v_perm_b32 v229, v239, v236, v235
    ds_write2_b32 v238, v228, v229 offset0:0 offset1:4
    v_add_u32 v238, 640, v238
    v_cndmask_b32 v237, v231, v230, s[6:7]
    v_cndmask_b32 v236, v230, v231, s[6:7]
    s_nop 0
    v_mov_b32_dpp v239, v237 quad_perm:[1,0,3,2] row_mask:0xf bank_mask:0xf
    v_perm_b32 v230, v239, v236, v234
    v_perm_b32 v231, v239, v236, v235
    ds_write2_b32 v238, v230, v231 offset0:0 offset1:4
    v_add_u32 v238, 640, v238
    v_cndmask_b32 v237, v233, v232, s[6:7]
    v_cndmask_b32 v236, v232, v233, s[6:7]
    s_nop 0
    v_mov_b32_dpp v239, v237 quad_perm:[1,0,3,2] row_mask:0xf bank_mask:0xf
    v_perm_b32 v232, v239, v236, v234
    v_perm_b32 v233, v239, v236, v235
    ds_write2_b32 v238, v232, v233 offset0:0 offset1:4
    v_and_b32 v239, 63, v252
    v_mul_u32_u24 v239, 80, v239
    v_add_u32 v239, s49, v239
    s_waitcnt lgkmcnt(0)
    v_mov_b64 v[224:225], 0
    v_mov_b64 v[226:227], 0
    v_mov_b64 v[228:229], 0
    v_mov_b64 v[230:231], 0
    s_mov_b64 exec, s[46:47]
    ds_write_b128 v239, v[224:227] offset:64
    s_mov_b64 exec, -1
    ds_read_b128 v[232:235], v248 offset:0
    ds_read_b128 v[236:239], v248 offset:0
    s_mul_i32 s4, s51, 80
    s_lshl_b32 s5, s51, 5
    v_subrev_u32 v248, s4, v248
    v_subrev_u32 v253, s5, v253
    s_mul_i32 s5, s16, 625
    s_add_u32 s6, s5, 640
    s_add_u32 s5, s5, 15
    s_lshr_b32 s5, s5, 4
    s_lshr_b32 s6, s6, 4
    s_sub_u32 s7, s6, s5
    s_cmp_eq_u32 s7, 40
    s_cselect_b32 s54, -1, 0x7f7f7f7f
    s_and_b32 s52, s54, 0x00ff00ff
    s_mov_b32 s53, s52
    s_mov_b32 s55, s54
    s_lshl_b32 s5, s5, 10
    s_and_b32 s6, s17, 3
    s_lshl_b32 s6, s6, 6
    s_add_u32 s5, s5, s6
    s_add_u32 s20, s12, s5
    s_addc_u32 s21, s13, 0
    s_add_u32 s22, s20, 16384
    s_addc_u32 s23, s21, 0
    s_add_u32 s24, s20, 32768
    s_addc_u32 s25, s21, 0
    s_and_b32 s4, s17, 3
    s_mul_i32 s4, s4, 40960
    s_add_u32 s4, s4, 7344128
    s_add_u32 s26, s14, s4
    s_addc_u32 s27, s15, 0
    s_barrier
    s_cmp_le_u32 s43, 0
    s_cbranch_scc1 L2_f0
    s_cmp_le_u32 s43, 1
    s_cbranch_scc1 L2_f1
    s_cmp_le_u32 s43, 2
    s_cbranch_scc1 L2_f2
    s_cmp_le_u32 s43, 3
    s_cbranch_scc1 L2_f3
    s_cmp_le_u32 s43, 4
    s_cbranch_scc1 L2_f4
    s_cmp_le_u32 s43, 5
    s_cbranch_scc1 L2_f5
    s_cmp_le_u32 s43, 6
    s_cbranch_scc1 L2_f6
    s_cmp_le_u32 s43, 7
    s_cbranch_scc1 L2_f7
    s_branch L2_f8
L2_f0:
    s_waitcnt vmcnt(0)
L2_f1:
    s_waitcnt vmcnt(1)
L2_f2:
    s_waitcnt vmcnt(2)
L2_f3:
    s_waitcnt vmcnt(3)
L2_f4:
    s_waitcnt vmcnt(4)
L2_f5:
    s_waitcnt vmcnt(5)
L2_f6:
    s_waitcnt vmcnt(6)
L2_f7:
    s_waitcnt vmcnt(7)
L2_f8:
    s_waitcnt vmcnt(8)
    s_waitcnt lgkmcnt(0)
    s_cmp_ge_u32 s59, 160
    s_cbranch_scc1 L2_nfl
    s_lshl_b32 s4, s59, 3
    s_add_u32 s4, s4, 7864320
    v_mov_b32 v240, s4
    v_mov_b32 v254, s56
    v_mov_b32 v255, s58
    s_mov_b64 exec, 1
    global_store_dwordx2 v240, v[254:255], s[14:15] sc1
    s_mov_b64 exec, -1
L2_nfl:
    s_mov_b32 s59, 161
    v_mov_b32 v255, -1
    s_cmp_eq_u32 s51, 1
    s_cbranch_scc1 L2_g5
.p2align 6
L2_sweep:
L2_g0:
    ds_read_b128 v[240:243], v253 offset:26240
    ds_read_b128 v[244:247], v253 offset:26256
    ds_read_b128 v[236:239], v248 offset:640
    s_cmp_gt_u32 s38, 6
    s_cbranch_scc1 L2_v4_0
    s_cmp_gt_u32 s38, 4
    s_cbranch_scc1 L2_v3_0
    s_cmp_eq_u32 s38, 0
    s_cbranch_scc1 L2_skip0
    v_perm_b32 v224, v164, v160, s18
    v_perm_b32 v225, v172, v168, s18
    v_perm_b32 v228, v164, v160, s19
    v_perm_b32 v229, v172, v168, s19
    v_mfma_f32_16x16x16_bf16 v[0:3], v[232:233], v[224:225], v[0:3]
    v_perm_b32 v224, v165, v161, s18
    v_perm_b32 v225, v173, v169, s18
    v_mfma_f32_16x16x16_bf16 v[4:7], v[232:233], v[228:229], v[4:7]
    v_perm_b32 v228, v165, v161, s19
    v_perm_b32 v229, v173, v169, s19
    v_mfma_f32_16x16x16_bf16 v[8:11], v[232:233], v[224:225], v[8:11]
    v_perm_b32 v224, v166, v162, s18
    v_perm_b32 v225, v174, v170, s18
    v_mfma_f32_16x16x16_bf16 v[12:15], v[232:233], v[228:229], v[12:15]
    v_perm_b32 v228, v166, v162, s19
    v_perm_b32 v229, v174, v170, s19
    v_mfma_f32_16x16x16_bf16 v[16:19], v[232:233], v[224:225], v[16:19]
    v_perm_b32 v224, v167, v163, s18
    v_perm_b32 v225, v175, v171, s18
    v_mfma_f32_16x16x16_bf16 v[20:23], v[232:233], v[228:229], v[20:23]
    v_perm_b32 v228, v167, v163, s19
    v_perm_b32 v229, v175, v171, s19
    v_mfma_f32_16x16x16_bf16 v[24:27], v[232:233], v[224:225], v[24:27]
    s_nop 0
    v_mfma_f32_16x16x16_bf16 v[28:31], v[232:233], v[228:229], v[28:31]
    s_branch L2_skip0
L2_v3_0:
    v_perm_b32 v224, v164, v160, s18
    v_perm_b32 v225, v172, v168, s18
    v_perm_b32 v226, v180, v176, s18
    v_perm_b32 v228, v164, v160, s19
    v_perm_b32 v229, v172, v168, s19
    v_perm_b32 v230, v180, v176, s19
    v_mfma_f32_16x16x32_bf16 v[0:3], v[232:235], v[224:227], v[0:3]
    v_perm_b32 v224, v165, v161, s18
    v_perm_b32 v225, v173, v169, s18
    v_perm_b32 v226, v181, v177, s18
    v_mfma_f32_16x16x32_bf16 v[4:7], v[232:235], v[228:231], v[4:7]
    v_perm_b32 v228, v165, v161, s19
    v_perm_b32 v229, v173, v169, s19
    v_perm_b32 v230, v181, v177, s19
    v_mfma_f32_16x16x32_bf16 v[8:11], v[232:235], v[224:227], v[8:11]
    v_perm_b32 v224, v166, v162, s18
    v_perm_b32 v225, v174, v170, s18
    v_perm_b32 v226, v182, v178, s18
    v_mfma_f32_16x16x32_bf16 v[12:15], v[232:235], v[228:231], v[12:15]
    v_perm_b32 v228, v166, v162, s19
    v_perm_b32 v229, v174, v170, s19
    v_perm_b32 v230, v182, v178, s19
    v_mfma_f32_16x16x32_bf16 v[16:19], v[232:235], v[224:227], v[16:19]
    v_perm_b32 v224, v167, v163, s18
    v_perm_b32 v225, v175, v171, s18
    v_perm_b32 v226, v183, v179, s18
    v_mfma_f32_16x16x32_bf16 v[20:23], v[232:235], v[228:231], v[20:23]
    v_perm_b32 v228, v167, v163, s19
    v_perm_b32 v229, v175, v171, s19
    v_perm_b32 v230, v183, v179, s19
    v_mfma_f32_16x16x32_bf16 v[24:27], v[232:235], v[224:227], v[24:27]
    s_nop 0
    v_mfma_f32_16x16x32_bf16 v[28:31], v[232:235], v[228:231], v[28:31]
    s_branch L2_skip0
L2_v4_0:
    v_perm_b32 v224, v164, v160, s18
    v_perm_b32 v225, v172, v168, s18
    v_perm_b32 v226, v180, v176, s18
    v_perm_b32 v227, v188, v184, s18
    v_perm_b32 v228, v164, v160, s19
    v_perm_b32 v229, v172, v168, s19
    v_perm_b32 v230, v180, v176, s19
    v_perm_b32 v231, v188, v184, s19
    v_mfma_f32_16x16x32_bf16 v[0:3], v[232:235], v[224:227], v[0:3]
    v_perm_b32 v224, v165, v161, s18
    v_perm_b32 v225, v173, v169, s18
    v_perm_b32 v226, v181, v177, s18
    v_perm_b32 v227, v189, v185, s18
    v_mfma_f32_16x16x32_bf16 v[4:7], v[232:235], v[228:231], v[4:7]
    v_perm_b32 v228, v165, v161, s19
    v_perm_b32 v229, v173, v169, s19
    v_perm_b32 v230, v181, v177, s19
    v_perm_b32 v231, v189, v185, s19
    v_mfma_f32_16x16x32_bf16 v[8:11], v[232:235], v[224:227], v[8:11]
    v_perm_b32 v224, v166, v162, s18
    v_perm_b32 v225, v174, v170, s18
    v_perm_b32 v226, v182, v178, s18
    v_perm_b32 v227, v190, v186, s18
    v_mfma_f32_16x16x32_bf16 v[12:15], v[232:235], v[228:231], v[12:15]
    v_perm_b32 v228, v166, v162, s19
    v_perm_b32 v229, v174, v170, s19
    v_perm_b32 v230, v182, v178, s19
    v_perm_b32 v231, v190, v186, s19
    v_mfma_f32_16x16x32_bf16 v[16:19], v[232:235], v[224:227], v[16:19]
    v_perm_b32 v224, v167, v163, s18
    v_perm_b32 v225, v175, v171, s18
    v_perm_b32 v226, v183, v179, s18
    v_perm_b32 v227, v191, v187, s18
    v_mfma_f32_16x16x32_bf16 v[20:23], v[232:235], v[228:231], v[20:23]
    v_perm_b32 v228, v167, v163, s19
    v_perm_b32 v229, v175, v171, s19
    v_perm_b32 v230, v183, v179, s19
    v_perm_b32 v231, v191, v187, s19
    v_mfma_f32_16x16x32_bf16 v[24:27], v[232:235], v[224:227], v[24:27]
    s_nop 0
    v_mfma_f32_16x16x32_bf16 v[28:31], v[232:235], v[228:231], v[28:31]
L2_skip0:
    s_and_b32 s38, s32, 0xff
    s_bcnt1_i32_b32 s38, s38
    s_lshr_b64 s[32:33], s[32:33], 8
    s_waitcnt lgkmcnt(0)
    s_cmp_le_u32 s38, 0
    s_cbranch_scc1 L2_w4_0
    buffer_load_dwordx4 v[160:163], v240, s[8:11], 0 offen
    s_cmp_le_u32 s38, 1
    s_cbranch_scc1 L2_w4_1
    buffer_load_dwordx4 v[164:167], v241, s[8:11], 0 offen
    s_cmp_le_u32 s38, 2
    s_cbranch_scc1 L2_w4_2
    buffer_load_dwordx4 v[168:171], v242, s[8:11], 0 offen
    s_cmp_le_u32 s38, 3
    s_cbranch_scc1 L2_w4_3
    buffer_load_dwordx4 v[172:175], v243, s[8:11], 0 offen
    s_cmp_le_u32 s38, 4
    s_cbranch_scc1 L2_w4_4
    buffer_load_dwordx4 v[176:179], v244, s[8:11], 0 offen
    s_cmp_le_u32 s38, 5
    s_cbranch_scc1 L2_w4_5
    buffer_load_dwordx4 v[180:183], v245, s[8:11], 0 offen
    s_cmp_le_u32 s38, 6
    s_cbranch_scc1 L2_w4_6
    buffer_load_dwordx4 v[184:187], v246, s[8:11], 0 offen
    s_cmp_le_u32 s38, 7
    s_cbranch_scc1 L2_w4_7
    buffer_load_dwordx4 v[188:191], v247, s[8:11], 0 offen
    s_branch L2_w4_8
L2_w4_0:
    s_waitcnt vmcnt(0)
L2_w4_1:
    s_waitcnt vmcnt(1)
L2_w4_2:
    s_waitcnt vmcnt(2)
L2_w4_3:
    s_waitcnt vmcnt(3)
L2_w4_4:
    s_waitcnt vmcnt(4)
L2_w4_5:
    s_waitcnt vmcnt(5)
L2_w4_6:
    s_waitcnt vmcnt(6)
L2_w4_7:
    s_waitcnt vmcnt(7)
L2_w4_8:
    s_waitcnt vmcnt(8)
L2_g1:
    ds_read_b128 v[240:243], v253 offset:26496
    ds_read_b128 v[244:247], v253 offset:26512
    ds_read_b128 v[232:235], v248 offset:1280
    s_cmp_gt_u32 s39, 6
    s_cbranch_scc1 L2_v4_1
    s_cmp_gt_u32 s39, 4
    s_cbranch_scc1 L2_v3_1
    s_cmp_eq_u32 s39, 0
    s_cbranch_scc1 L2_skip1
    v_perm_b32 v224, v196, v192, s18
    v_perm_b32 v225, v204, v200, s18
    v_perm_b32 v228, v196, v192, s19
    v_perm_b32 v229, v204, v200, s19
    v_mfma_f32_16x16x16_bf16 v[32:35], v[236:237], v[224:225], v[32:35]
    v_perm_b32 v224, v197, v193, s18
    v_perm_b32 v225, v205, v201, s18
    v_mfma_f32_16x16x16_bf16 v[36:39], v[236:237], v[228:229], v[36:39]
    v_perm_b32 v228, v197, v193, s19
    v_perm_b32 v229, v205, v201, s19
    v_mfma_f32_16x16x16_bf16 v[40:43], v[236:237], v[224:225], v[40:43]
    v_perm_b32 v224, v198, v194, s18
    v_perm_b32 v225, v206, v202, s18
    v_mfma_f32_16x16x16_bf16 v[44:47], v[236:237], v[228:229], v[44:47]
    v_perm_b32 v228, v198, v194, s19
    v_perm_b32 v229, v206, v202, s19
    v_mfma_f32_16x16x16_bf16 v[48:51], v[236:237], v[224:225], v[48:51]
    v_perm_b32 v224, v199, v195, s18
    v_perm_b32 v225, v207, v203, s18
    v_mfma_f32_16x16x16_bf16 v[52:55], v[236:237], v[228:229], v[52:55]
    v_perm_b32 v228, v199, v195, s19
    v_perm_b32 v229, v207, v203, s19
    v_mfma_f32_16x16x16_bf16 v[56:59], v[236:237], v[224:225], v[56:59]
    s_nop 0
    v_mfma_f32_16x16x16_bf16 v[60:63], v[236:237], v[228:229], v[60:63]
    s_branch L2_skip1
L2_v3_1:
    v_perm_b32 v224, v196, v192, s18
    v_perm_b32 v225, v204, v200, s18
    v_perm_b32 v226, v212, v208, s18
    v_perm_b32 v228, v196, v192, s19
    v_perm_b32 v229, v204, v200, s19
    v_perm_b32 v230, v212, v208, s19
    v_mfma_f32_16x16x32_bf16 v[32:35], v[236:239], v[224:227], v[32:35]
    v_perm_b32 v224, v197, v193, s18
    v_perm_b32 v225, v205, v201, s18
    v_perm_b32 v226, v213, v209, s18
    v_mfma_f32_16x16x32_bf16 v[36:39], v[236:239], v[228:231], v[36:39]
    v_perm_b32 v228, v197, v193, s19
    v_perm_b32 v229, v205, v201, s19
    v_perm_b32 v230, v213, v209, s19
    v_mfma_f32_16x16x32_bf16 v[40:43], v[236:239], v[224:227], v[40:43]
    v_perm_b32 v224, v198, v194, s18
    v_perm_b32 v225, v206, v202, s18
    v_perm_b32 v226, v214, v210, s18
    v_mfma_f32_16x16x32_bf16 v[44:47], v[236:239], v[228:231], v[44:47]
    v_perm_b32 v228, v198, v194, s19
    v_perm_b32 v229, v206, v202, s19
    v_perm_b32 v230, v214, v210, s19
    v_mfma_f32_16x16x32_bf16 v[48:51], v[236:239], v[224:227], v[48:51]
    v_perm_b32 v224, v199, v195, s18
    v_perm_b32 v225, v207, v203, s18
    v_perm_b32 v226, v215, v211, s18
    v_mfma_f32_16x16x32_bf16 v[52:55], v[236:239], v[228:231], v[52:55]
    v_perm_b32 v228, v199, v195, s19
    v_perm_b32 v229, v207, v203, s19
    v_perm_b32 v230, v215, v211, s19
    v_mfma_f32_16x16x32_bf16 v[56:59], v[236:239], v[224:227], v[56:59]
    s_nop 0
    v_mfma_f32_16x16x32_bf16 v[60:63], v[236:239], v[228:231], v[60:63]
    s_branch L2_skip1
L2_v4_1:
    v_perm_b32 v224, v196, v192, s18
    v_perm_b32 v225, v204, v200, s18
    v_perm_b32 v226, v212, v208, s18
    v_perm_b32 v227, v220, v216, s18
    v_perm_b32 v228, v196, v192, s19
    v_perm_b32 v229, v204, v200, s19
    v_perm_b32 v230, v212, v208, s19
    v_perm_b32 v231, v220, v216, s19
    v_mfma_f32_16x16x32_bf16 v[32:35], v[236:239], v[224:227], v[32:35]
    v_perm_b32 v224, v197, v193, s18
    v_perm_b32 v225, v205, v201, s18
    v_perm_b32 v226, v213, v209, s18
    v_perm_b32 v227, v221, v217, s18
    v_mfma_f32_16x16x32_bf16 v[36:39], v[236:239], v[228:231], v[36:39]
    v_perm_b32 v228, v197, v193, s19
    v_perm_b32 v229, v205, v201, s19
    v_perm_b32 v230, v213, v209, s19
    v_perm_b32 v231, v221, v217, s19
    v_mfma_f32_16x16x32_bf16 v[40:43], v[236:239], v[224:227], v[40:43]
    v_perm_b32 v224, v198, v194, s18
    v_perm_b32 v225, v206, v202, s18
    v_perm_b32 v226, v214, v210, s18
    v_perm_b32 v227, v222, v218, s18
    v_mfma_f32_16x16x32_bf16 v[44:47], v[236:239], v[228:231], v[44:47]
    v_perm_b32 v228, v198, v194, s19
    v_perm_b32 v229, v206, v202, s19
    v_perm_b32 v230, v214, v210, s19
    v_perm_b32 v231, v222, v218, s19
    v_mfma_f32_16x16x32_bf16 v[48:51], v[236:239], v[224:227], v[48:51]
    v_perm_b32 v224, v199, v195, s18
    v_perm_b32 v225, v207, v203, s18
    v_perm_b32 v226, v215, v211, s18
    v_perm_b32 v227, v223, v219, s18
    v_mfma_f32_16x16x32_bf16 v[52:55], v[236:239], v[228:231], v[52:55]
    v_perm_b32 v228, v199, v195, s19
    v_perm_b32 v229, v207, v203, s19
    v_perm_b32 v230, v215, v211, s19
    v_perm_b32 v231, v223, v219, s19
    v_mfma_f32_16x16x32_bf16 v[56:59], v[236:239], v[224:227], v[56:59]
    s_nop 0
    v_mfma_f32_16x16x32_bf16 v[60:63], v[236:239], v[228:231], v[60:63]
L2_skip1:
    s_and_b32 s39, s34, 0xff
    s_bcnt1_i32_b32 s39, s39
    s_lshr_b64 s[34:35], s[34:35], 8
    s_waitcnt lgkmcnt(0)
    s_cmp_le_u32 s39, 0
    s_cbranch_scc1 L2_w5_0
    buffer_load_dwordx4 v[192:195], v240, s[8:11], 0 offen
    s_cmp_le_u32 s39, 1
    s_cbranch_scc1 L2_w5_1
    buffer_load_dwordx4 v[196:199], v241, s[8:11], 0 offen
    s_cmp_le_u32 s39, 2
    s_cbranch_scc1 L2_w5_2
    buffer_load_dwordx4 v[200:203], v242, s[8:11], 0 offen
    s_cmp_le_u32 s39, 3
    s_cbranch_scc1 L2_w5_3
    buffer_load_dwordx4 v[204:207], v243, s[8:11], 0 offen
    s_cmp_le_u32 s39, 4
    s_cbranch_scc1 L2_w5_4
    buffer_load_dwordx4 v[208:211], v244, s[8:11], 0 offen
    s_cmp_le_u32 s39, 5
    s_cbranch_scc1 L2_w5_5
    buffer_load_dwordx4 v[212:215], v245, s[8:11], 0 offen
    s_cmp_le_u32 s39, 6
    s_cbranch_scc1 L2_w5_6
    buffer_load_dwordx4 v[216:219], v246, s[8:11], 0 offen
    s_cmp_le_u32 s39, 7
    s_cbranch_scc1 L2_w5_7
    buffer_load_dwordx4 v[220:223], v247, s[8:11], 0 offen
    s_branch L2_w5_8
L2_w5_0:
    s_waitcnt vmcnt(0)
L2_w5_1:
    s_waitcnt vmcnt(1)
L2_w5_2:
    s_waitcnt vmcnt(2)
L2_w5_3:
    s_waitcnt vmcnt(3)
L2_w5_4:
    s_waitcnt vmcnt(4)
L2_w5_5:
    s_waitcnt vmcnt(5)
L2_w5_6:
    s_waitcnt vmcnt(6)
L2_w5_7:
    s_waitcnt vmcnt(7)
L2_w5_8:
    s_waitcnt vmcnt(8)
L2_g2:
    ds_read_b128 v[240:243], v253 offset:26752
    ds_read_b128 v[244:247], v253 offset:26768
    ds_read_b128 v[236:239], v248 offset:1920
    s_cmp_gt_u32 s38, 6
    s_cbranch_scc1 L2_v4_2
    s_cmp_gt_u32 s38, 4
    s_cbranch_scc1 L2_v3_2
    s_cmp_eq_u32 s38, 0
    s_cbranch_scc1 L2_skip2
    v_perm_b32 v224, v164, v160, s18
    v_perm_b32 v225, v172, v168, s18
    v_perm_b32 v228, v164, v160, s19
    v_perm_b32 v229, v172, v168, s19
    v_mfma_f32_16x16x16_bf16 v[64:67], v[232:233], v[224:225], v[64:67]
    v_perm_b32 v224, v165, v161, s18
    v_perm_b32 v225, v173, v169, s18
    v_mfma_f32_16x16x16_bf16 v[68:71], v[232:233], v[228:229], v[68:71]
    v_perm_b32 v228, v165, v161, s19
    v_perm_b32 v229, v173, v169, s19
    v_mfma_f32_16x16x16_bf16 v[72:75], v[232:233], v[224:225], v[72:75]
    v_perm_b32 v224, v166, v162, s18
    v_perm_b32 v225, v174, v170, s18
    v_mfma_f32_16x16x16_bf16 v[76:79], v[232:233], v[228:229], v[76:79]
    v_perm_b32 v228, v166, v162, s19
    v_perm_b32 v229, v174, v170, s19
    v_mfma_f32_16x16x16_bf16 v[80:83], v[232:233], v[224:225], v[80:83]
    v_perm_b32 v224, v167, v163, s18
    v_perm_b32 v225, v175, v171, s18
    v_mfma_f32_16x16x16_bf16 v[84:87], v[232:233], v[228:229], v[84:87]
    v_perm_b32 v228, v167, v163, s19
    v_perm_b32 v229, v175, v171, s19
    v_mfma_f32_16x16x16_bf16 v[88:91], v[232:233], v[224:225], v[88:91]
    s_nop 0
    v_mfma_f32_16x16x16_bf16 v[92:95], v[232:233], v[228:229], v[92:95]
    s_branch L2_skip2
L2_v3_2:
    v_perm_b32 v224, v164, v160, s18
    v_perm_b32 v225, v172, v168, s18
    v_perm_b32 v226, v180, v176, s18
    v_perm_b32 v228, v164, v160, s19
    v_perm_b32 v229, v172, v168, s19
    v_perm_b32 v230, v180, v176, s19
    v_mfma_f32_16x16x32_bf16 v[64:67], v[232:235], v[224:227], v[64:67]
    v_perm_b32 v224, v165, v161, s18
    v_perm_b32 v225, v173, v169, s18
    v_perm_b32 v226, v181, v177, s18
    v_mfma_f32_16x16x32_bf16 v[68:71], v[232:235], v[228:231], v[68:71]
    v_perm_b32 v228, v165, v161, s19
    v_perm_b32 v229, v173, v169, s19
    v_perm_b32 v230, v181, v177, s19
    v_mfma_f32_16x16x32_bf16 v[72:75], v[232:235], v[224:227], v[72:75]
    v_perm_b32 v224, v166, v162, s18
    v_perm_b32 v225, v174, v170, s18
    v_perm_b32 v226, v182, v178, s18
    v_mfma_f32_16x16x32_bf16 v[76:79], v[232:235], v[228:231], v[76:79]
    v_perm_b32 v228, v166, v162, s19
    v_perm_b32 v229, v174, v170, s19
    v_perm_b32 v230, v182, v178, s19
    v_mfma_f32_16x16x32_bf16 v[80:83], v[232:235], v[224:227], v[80:83]
    v_perm_b32 v224, v167, v163, s18
    v_perm_b32 v225, v175, v171, s18
    v_perm_b32 v226, v183, v179, s18
    v_mfma_f32_16x16x32_bf16 v[84:87], v[232:235], v[228:231], v[84:87]
    v_perm_b32 v228, v167, v163, s19
    v_perm_b32 v229, v175, v171, s19
    v_perm_b32 v230, v183, v179, s19
    v_mfma_f32_16x16x32_bf16 v[88:91], v[232:235], v[224:227], v[88:91]
    s_nop 0
    v_mfma_f32_16x16x32_bf16 v[92:95], v[232:235], v[228:231], v[92:95]
    s_branch L2_skip2
L2_v4_2:
    v_perm_b32 v224, v164, v160, s18
    v_perm_b32 v225, v172, v168, s18
    v_perm_b32 v226, v180, v176, s18
    v_perm_b32 v227, v188, v184, s18
    v_perm_b32 v228, v164, v160, s19
    v_perm_b32 v229, v172, v168, s19
    v_perm_b32 v230, v180, v176, s19
    v_perm_b32 v231, v188, v184, s19
    v_mfma_f32_16x16x32_bf16 v[64:67], v[232:235], v[224:227], v[64:67]
    v_perm_b32 v224, v165, v161, s18
    v_perm_b32 v225, v173, v169, s18
    v_perm_b32 v226, v181, v177, s18
    v_perm_b32 v227, v189, v185, s18
    v_mfma_f32_16x16x32_bf16 v[68:71], v[232:235], v[228:231], v[68:71]
    v_perm_b32 v228, v165, v161, s19
    v_perm_b32 v229, v173, v169, s19
    v_perm_b32 v230, v181, v177, s19
    v_perm_b32 v231, v189, v185, s19
    v_mfma_f32_16x16x32_bf16 v[72:75], v[232:235], v[224:227], v[72:75]
    v_perm_b32 v224, v166, v162, s18
    v_perm_b32 v225, v174, v170, s18
    v_perm_b32 v226, v182, v178, s18
    v_perm_b32 v227, v190, v186, s18
    v_mfma_f32_16x16x32_bf16 v[76:79], v[232:235], v[228:231], v[76:79]
    v_perm_b32 v228, v166, v162, s19
    v_perm_b32 v229, v174, v170, s19
    v_perm_b32 v230, v182, v178, s19
    v_perm_b32 v231, v190, v186, s19
    v_mfma_f32_16x16x32_bf16 v[80:83], v[232:235], v[224:227], v[80:83]
    v_perm_b32 v224, v167, v163, s18
    v_perm_b32 v225, v175, v171, s18
    v_perm_b32 v226, v183, v179, s18
    v_perm_b32 v227, v191, v187, s18
    v_mfma_f32_16x16x32_bf16 v[84:87], v[232:235], v[228:231], v[84:87]
    v_perm_b32 v228, v167, v163, s19
    v_perm_b32 v229, v175, v171, s19
    v_perm_b32 v230, v183, v179, s19
    v_perm_b32 v231, v191, v187, s19
    v_mfma_f32_16x16x32_bf16 v[88:91], v[232:235], v[224:227], v[88:91]
    s_nop 0
    v_mfma_f32_16x16x32_bf16 v[92:95], v[232:235], v[228:231], v[92:95]
L2_skip2:
    s_and_b32 s38, s36, 0xff
    s_bcnt1_i32_b32 s38, s38
    s_lshr_b64 s[36:37], s[36:37], 8
    s_waitcnt lgkmcnt(0)
    s_cmp_le_u32 s38, 0
    s_cbranch_scc1 L2_w6_0
    buffer_load_dwordx4 v[160:163], v240, s[8:11], 0 offen
    s_cmp_le_u32 s38, 1
    s_cbranch_scc1 L2_w6_1
    buffer_load_dwordx4 v[164:167], v241, s[8:11], 0 offen
    s_cmp_le_u32 s38, 2
    s_cbranch_scc1 L2_w6_2
    buffer_load_dwordx4 v[168:171], v242, s[8:11], 0 offen
    s_cmp_le_u32 s38, 3
    s_cbranch_scc1 L2_w6_3
    buffer_load_dwordx4 v[172:175], v243, s[8:11], 0 offen
    s_cmp_le_u32 s38, 4
    s_cbranch_scc1 L2_w6_4
    buffer_load_dwordx4 v[176:179], v244, s[8:11], 0 offen
    s_cmp_le_u32 s38, 5
    s_cbranch_scc1 L2_w6_5
    buffer_load_dwordx4 v[180:183], v245, s[8:11], 0 offen
    s_cmp_le_u32 s38, 6
    s_cbranch_scc1 L2_w6_6
    buffer_load_dwordx4 v[184:187], v246, s[8:11], 0 offen
    s_cmp_le_u32 s38, 7
    s_cbranch_scc1 L2_w6_7
    buffer_load_dwordx4 v[188:191], v247, s[8:11], 0 offen
    s_branch L2_w6_8
L2_w6_0:
    s_waitcnt vmcnt(0)
L2_w6_1:
    s_waitcnt vmcnt(1)
L2_w6_2:
    s_waitcnt vmcnt(2)
L2_w6_3:
    s_waitcnt vmcnt(3)
L2_w6_4:
    s_waitcnt vmcnt(4)
L2_w6_5:
    s_waitcnt vmcnt(5)
L2_w6_6:
    s_waitcnt vmcnt(6)
L2_w6_7:
    s_waitcnt vmcnt(7)
L2_w6_8:
    s_waitcnt vmcnt(8)
L2_g3:
    ds_read_b128 v[240:243], v253 offset:25760
    ds_read_b128 v[244:247], v253 offset:25776
    ds_read_b128 v[232:235], v248 offset:2560
    s_cmp_gt_u32 s39, 6
    s_cbranch_scc1 L2_v4_3
    s_cmp_gt_u32 s39, 4
    s_cbranch_scc1 L2_v3_3
    s_cmp_eq_u32 s39, 0
    s_cbranch_scc1 L2_skip3
    v_perm_b32 v224, v196, v192, s18
    v_perm_b32 v225, v204, v200, s18
    v_perm_b32 v228, v196, v192, s19
    v_perm_b32 v229, v204, v200, s19
    v_mfma_f32_16x16x16_bf16 v[96:99], v[236:237], v[224:225], v[96:99]
    v_perm_b32 v224, v197, v193, s18
    v_perm_b32 v225, v205, v201, s18
    v_mfma_f32_16x16x16_bf16 v[100:103], v[236:237], v[228:229], v[100:103]
    v_perm_b32 v228, v197, v193, s19
    v_perm_b32 v229, v205, v201, s19
    v_mfma_f32_16x16x16_bf16 v[104:107], v[236:237], v[224:225], v[104:107]
    v_perm_b32 v224, v198, v194, s18
    v_perm_b32 v225, v206, v202, s18
    v_mfma_f32_16x16x16_bf16 v[108:111], v[236:237], v[228:229], v[108:111]
    v_perm_b32 v228, v198, v194, s19
    v_perm_b32 v229, v206, v202, s19
    v_mfma_f32_16x16x16_bf16 v[112:115], v[236:237], v[224:225], v[112:115]
    v_perm_b32 v224, v199, v195, s18
    v_perm_b32 v225, v207, v203, s18
    v_mfma_f32_16x16x16_bf16 v[116:119], v[236:237], v[228:229], v[116:119]
    v_perm_b32 v228, v199, v195, s19
    v_perm_b32 v229, v207, v203, s19
    v_mfma_f32_16x16x16_bf16 v[120:123], v[236:237], v[224:225], v[120:123]
    s_nop 0
    v_mfma_f32_16x16x16_bf16 v[124:127], v[236:237], v[228:229], v[124:127]
    s_branch L2_skip3
L2_v3_3:
    v_perm_b32 v224, v196, v192, s18
    v_perm_b32 v225, v204, v200, s18
    v_perm_b32 v226, v212, v208, s18
    v_perm_b32 v228, v196, v192, s19
    v_perm_b32 v229, v204, v200, s19
    v_perm_b32 v230, v212, v208, s19
    v_mfma_f32_16x16x32_bf16 v[96:99], v[236:239], v[224:227], v[96:99]
    v_perm_b32 v224, v197, v193, s18
    v_perm_b32 v225, v205, v201, s18
    v_perm_b32 v226, v213, v209, s18
    v_mfma_f32_16x16x32_bf16 v[100:103], v[236:239], v[228:231], v[100:103]
    v_perm_b32 v228, v197, v193, s19
    v_perm_b32 v229, v205, v201, s19
    v_perm_b32 v230, v213, v209, s19
    v_mfma_f32_16x16x32_bf16 v[104:107], v[236:239], v[224:227], v[104:107]
    v_perm_b32 v224, v198, v194, s18
    v_perm_b32 v225, v206, v202, s18
    v_perm_b32 v226, v214, v210, s18
    v_mfma_f32_16x16x32_bf16 v[108:111], v[236:239], v[228:231], v[108:111]
    v_perm_b32 v228, v198, v194, s19
    v_perm_b32 v229, v206, v202, s19
    v_perm_b32 v230, v214, v210, s19
    v_mfma_f32_16x16x32_bf16 v[112:115], v[236:239], v[224:227], v[112:115]
    v_perm_b32 v224, v199, v195, s18
    v_perm_b32 v225, v207, v203, s18
    v_perm_b32 v226, v215, v211, s18
    v_mfma_f32_16x16x32_bf16 v[116:119], v[236:239], v[228:231], v[116:119]
    v_perm_b32 v228, v199, v195, s19
    v_perm_b32 v229, v207, v203, s19
    v_perm_b32 v230, v215, v211, s19
    v_mfma_f32_16x16x32_bf16 v[120:123], v[236:239], v[224:227], v[120:123]
    s_nop 0
    v_mfma_f32_16x16x32_bf16 v[124:127], v[236:239], v[228:231], v[124:127]
    s_branch L2_skip3
L2_v4_3:
    v_perm_b32 v224, v196, v192, s18
    v_perm_b32 v225, v204, v200, s18
    v_perm_b32 v226, v212, v208, s18
    v_perm_b32 v227, v220, v216, s18
    v_perm_b32 v228, v196, v192, s19
    v_perm_b32 v229, v204, v200, s19
    v_perm_b32 v230, v212, v208, s19
    v_perm_b32 v231, v220, v216, s19
    v_mfma_f32_16x16x32_bf16 v[96:99], v[236:239], v[224:227], v[96:99]
    v_perm_b32 v224, v197, v193, s18
    v_perm_b32 v225, v205, v201, s18
    v_perm_b32 v226, v213, v209, s18
    v_perm_b32 v227, v221, v217, s18
    v_mfma_f32_16x16x32_bf16 v[100:103], v[236:239], v[228:231], v[100:103]
    v_perm_b32 v228, v197, v193, s19
    v_perm_b32 v229, v205, v201, s19
    v_perm_b32 v230, v213, v209, s19
    v_perm_b32 v231, v221, v217, s19
    v_mfma_f32_16x16x32_bf16 v[104:107], v[236:239], v[224:227], v[104:107]
    v_perm_b32 v224, v198, v194, s18
    v_perm_b32 v225, v206, v202, s18
    v_perm_b32 v226, v214, v210, s18
    v_perm_b32 v227, v222, v218, s18
    v_mfma_f32_16x16x32_bf16 v[108:111], v[236:239], v[228:231], v[108:111]
    v_perm_b32 v228, v198, v194, s19
    v_perm_b32 v229, v206, v202, s19
    v_perm_b32 v230, v214, v210, s19
    v_perm_b32 v231, v222, v218, s19
    v_mfma_f32_16x16x32_bf16 v[112:115], v[236:239], v[224:227], v[112:115]
    v_perm_b32 v224, v199, v195, s18
    v_perm_b32 v225, v207, v203, s18
    v_perm_b32 v226, v215, v211, s18
    v_perm_b32 v227, v223, v219, s18
    v_mfma_f32_16x16x32_bf16 v[116:119], v[236:239], v[228:231], v[116:119]
    v_perm_b32 v228, v199, v195, s19
    v_perm_b32 v229, v207, v203, s19
    v_perm_b32 v230, v215, v211, s19
    v_perm_b32 v231, v223, v219, s19
    v_mfma_f32_16x16x32_bf16 v[120:123], v[236:239], v[224:227], v[120:123]
    s_nop 0
    v_mfma_f32_16x16x32_bf16 v[124:127], v[236:239], v[228:231], v[124:127]
L2_skip3:
    s_and_b32 s39, s28, 0xff
    s_bcnt1_i32_b32 s39, s39
    s_lshr_b64 s[28:29], s[28:29], 8
    s_waitcnt lgkmcnt(0)
    s_cmp_le_u32 s39, 0
    s_cbranch_scc1 L2_w7_0
    buffer_load_dwordx4 v[192:195], v240, s[8:11], 0 offen
    s_cmp_le_u32 s39, 1
    s_cbranch_scc1 L2_w7_1
    buffer_load_dwordx4 v[196:199], v241, s[8:11], 0 offen
    s_cmp_le_u32 s39, 2
    s_cbranch_scc1 L2_w7_2
    buffer_load_dwordx4 v[200:203], v242, s[8:11], 0 offen
    s_cmp_le_u32 s39, 3
    s_cbranch_scc1 L2_w7_3
    buffer_load_dwordx4 v[204:207], v243, s[8:11], 0 offen
    s_cmp_le_u32 s39, 4
    s_cbranch_scc1 L2_w7_4
    buffer_load_dwordx4 v[208:211], v244, s[8:11], 0 offen
    s_cmp_le_u32 s39, 5
    s_cbranch_scc1 L2_w7_5
    buffer_load_dwordx4 v[212:215], v245, s[8:11], 0 offen
    s_cmp_le_u32 s39, 6
    s_cbranch_scc1 L2_w7_6
    buffer_load_dwordx4 v[216:219], v246, s[8:11], 0 offen
    s_cmp_le_u32 s39, 7
    s_cbranch_scc1 L2_w7_7
    buffer_load_dwordx4 v[220:223], v247, s[8:11], 0 offen
    s_branch L2_w7_8
L2_w7_0:
    s_waitcnt vmcnt(0)
L2_w7_1:
    s_waitcnt vmcnt(1)
L2_w7_2:
    s_waitcnt vmcnt(2)
L2_w7_3:
    s_waitcnt vmcnt(3)
L2_w7_4:
    s_waitcnt vmcnt(4)
L2_w7_5:
    s_waitcnt vmcnt(5)
L2_w7_6:
    s_waitcnt vmcnt(6)
L2_w7_7:
    s_waitcnt vmcnt(7)
L2_w7_8:
    s_waitcnt vmcnt(8)
L2_g4:
    ds_read_b128 v[240:243], v253 offset:26016
    ds_read_b128 v[244:247], v253 offset:26032
    ds_read_b128 v[236:239], v248 offset:80
    s_cmp_gt_u32 s38, 6
    s_cbranch_scc1 L2_v4_4
    s_cmp_gt_u32 s38, 4
    s_cbranch_scc1 L2_v3_4
    s_cmp_eq_u32 s38, 0
    s_cbranch_scc1 L2_skip4
    v_perm_b32 v224, v164, v160, s18
    v_perm_b32 v225, v172, v168, s18
    v_perm_b32 v228, v164, v160, s19
    v_perm_b32 v229, v172, v168, s19
    v_mfma_f32_16x16x16_bf16 v[128:131], v[232:233], v[224:225], v[128:131]
    v_perm_b32 v224, v165, v161, s18
    v_perm_b32 v225, v173, v169, s18
    v_mfma_f32_16x16x16_bf16 v[132:135], v[232:233], v[228:229], v[132:135]
    v_perm_b32 v228, v165, v161, s19
    v_perm_b32 v229, v173, v169, s19
    v_mfma_f32_16x16x16_bf16 v[136:139], v[232:233], v[224:225], v[136:139]
    v_perm_b32 v224, v166, v162, s18
    v_perm_b32 v225, v174, v170, s18
    v_mfma_f32_16x16x16_bf16 v[140:143], v[232:233], v[228:229], v[140:143]
    v_perm_b32 v228, v166, v162, s19
    v_perm_b32 v229, v174, v170, s19
    v_mfma_f32_16x16x16_bf16 v[144:147], v[232:233], v[224:225], v[144:147]
    v_perm_b32 v224, v167, v163, s18
    v_perm_b32 v225, v175, v171, s18
    v_mfma_f32_16x16x16_bf16 v[148:151], v[232:233], v[228:229], v[148:151]
    v_perm_b32 v228, v167, v163, s19
    v_perm_b32 v229, v175, v171, s19
    v_mfma_f32_16x16x16_bf16 v[152:155], v[232:233], v[224:225], v[152:155]
    s_nop 0
    v_mfma_f32_16x16x16_bf16 v[156:159], v[232:233], v[228:229], v[156:159]
    s_branch L2_skip4
L2_v3_4:
    v_perm_b32 v224, v164, v160, s18
    v_perm_b32 v225, v172, v168, s18
    v_perm_b32 v226, v180, v176, s18
    v_perm_b32 v228, v164, v160, s19
    v_perm_b32 v229, v172, v168, s19
    v_perm_b32 v230, v180, v176, s19
    v_mfma_f32_16x16x32_bf16 v[128:131], v[232:235], v[224:227], v[128:131]
    v_perm_b32 v224, v165, v161, s18
    v_perm_b32 v225, v173, v169, s18
    v_perm_b32 v226, v181, v177, s18
    v_mfma_f32_16x16x32_bf16 v[132:135], v[232:235], v[228:231], v[132:135]
    v_perm_b32 v228, v165, v161, s19
    v_perm_b32 v229, v173, v169, s19
    v_perm_b32 v230, v181, v177, s19
    v_mfma_f32_16x16x32_bf16 v[136:139], v[232:235], v[224:227], v[136:139]
    v_perm_b32 v224, v166, v162, s18
    v_perm_b32 v225, v174, v170, s18
    v_perm_b32 v226, v182, v178, s18
    v_mfma_f32_16x16x32_bf16 v[140:143], v[232:235], v[228:231], v[140:143]
    v_perm_b32 v228, v166, v162, s19
    v_perm_b32 v229, v174, v170, s19
    v_perm_b32 v230, v182, v178, s19
    v_mfma_f32_16x16x32_bf16 v[144:147], v[232:235], v[224:227], v[144:147]
    v_perm_b32 v224, v167, v163, s18
    v_perm_b32 v225, v175, v171, s18
    v_perm_b32 v226, v183, v179, s18
    v_mfma_f32_16x16x32_bf16 v[148:151], v[232:235], v[228:231], v[148:151]
    v_perm_b32 v228, v167, v163, s19
    v_perm_b32 v229, v175, v171, s19
    v_perm_b32 v230, v183, v179, s19
    v_mfma_f32_16x16x32_bf16 v[152:155], v[232:235], v[224:227], v[152:155]
    s_nop 0
    v_mfma_f32_16x16x32_bf16 v[156:159], v[232:235], v[228:231], v[156:159]
    s_branch L2_skip4
L2_v4_4:
    v_perm_b32 v224, v164, v160, s18
    v_perm_b32 v225, v172, v168, s18
    v_perm_b32 v226, v180, v176, s18
    v_perm_b32 v227, v188, v184, s18
    v_perm_b32 v228, v164, v160, s19
    v_perm_b32 v229, v172, v168, s19
    v_perm_b32 v230, v180, v176, s19
    v_perm_b32 v231, v188, v184, s19
    v_mfma_f32_16x16x32_bf16 v[128:131], v[232:235], v[224:227], v[128:131]
    v_perm_b32 v224, v165, v161, s18
    v_perm_b32 v225, v173, v169, s18
    v_perm_b32 v226, v181, v177, s18
    v_perm_b32 v227, v189, v185, s18
    v_mfma_f32_16x16x32_bf16 v[132:135], v[232:235], v[228:231], v[132:135]
    v_perm_b32 v228, v165, v161, s19
    v_perm_b32 v229, v173, v169, s19
    v_perm_b32 v230, v181, v177, s19
    v_perm_b32 v231, v189, v185, s19
    v_mfma_f32_16x16x32_bf16 v[136:139], v[232:235], v[224:227], v[136:139]
    v_perm_b32 v224, v166, v162, s18
    v_perm_b32 v225, v174, v170, s18
    v_perm_b32 v226, v182, v178, s18
    v_perm_b32 v227, v190, v186, s18
    v_mfma_f32_16x16x32_bf16 v[140:143], v[232:235], v[228:231], v[140:143]
    v_perm_b32 v228, v166, v162, s19
    v_perm_b32 v229, v174, v170, s19
    v_perm_b32 v230, v182, v178, s19
    v_perm_b32 v231, v190, v186, s19
    v_mfma_f32_16x16x32_bf16 v[144:147], v[232:235], v[224:227], v[144:147]
    v_perm_b32 v224, v167, v163, s18
    v_perm_b32 v225, v175, v171, s18
    v_perm_b32 v226, v183, v179, s18
    v_perm_b32 v227, v191, v187, s18
    v_mfma_f32_16x16x32_bf16 v[148:151], v[232:235], v[228:231], v[148:151]
    v_perm_b32 v228, v167, v163, s19
    v_perm_b32 v229, v175, v171, s19
    v_perm_b32 v230, v183, v179, s19
    v_perm_b32 v231, v191, v187, s19
    v_mfma_f32_16x16x32_bf16 v[152:155], v[232:235], v[224:227], v[152:155]
    s_nop 0
    v_mfma_f32_16x16x32_bf16 v[156:159], v[232:235], v[228:231], v[156:159]
L2_skip4:
    s_and_b32 s38, s30, 0xff
    s_bcnt1_i32_b32 s38, s38
    s_lshr_b64 s[30:31], s[30:31], 8
    s_sub_u32 s40, s40, 1
    s_cmp_lg_u32 s40, 1
    s_cbranch_scc1 L2_nz
    v_and_b32 v254, 63, v252
    v_min_u32 v254, 39, v254
    s_and_b32 s4, s17, 3
    s_mul_i32 s4, s4, 320
    s_add_u32 s4, s4, 7864320
    v_lshl_add_u32 v254, v254, 3, s4
    global_load_dwordx2 v[254:255], v254, s[14:15] sc1
L2_nz:
    s_waitcnt lgkmcnt(0)
    s_cmp_le_u32 s38, 0
    s_cbranch_scc1 L2_w8_0
    buffer_load_dwordx4 v[160:163], v240, s[8:11], 0 offen
    s_cmp_le_u32 s38, 1
    s_cbranch_scc1 L2_w8_1
    buffer_load_dwordx4 v[164:167], v241, s[8:11], 0 offen
    s_cmp_le_u32 s38, 2
    s_cbranch_scc1 L2_w8_2
    buffer_load_dwordx4 v[168:171], v242, s[8:11], 0 offen
    s_cmp_le_u32 s38, 3
    s_cbranch_scc1 L2_w8_3
    buffer_load_dwordx4 v[172:175], v243, s[8:11], 0 offen
    s_cmp_le_u32 s38, 4
    s_cbranch_scc1 L2_w8_4
    buffer_load_dwordx4 v[176:179], v244, s[8:11], 0 offen
    s_cmp_le_u32 s38, 5
    s_cbranch_scc1 L2_w8_5
    buffer_load_dwordx4 v[180:183], v245, s[8:11], 0 offen
    s_cmp_le_u32 s38, 6
    s_cbranch_scc1 L2_w8_6
    buffer_load_dwordx4 v[184:187], v246, s[8:11], 0 offen
    s_cmp_le_u32 s38, 7
    s_cbranch_scc1 L2_w8_7
    buffer_load_dwordx4 v[188:191], v247, s[8:11], 0 offen
    s_branch L2_w8_8
L2_w8_0:
    s_waitcnt vmcnt(0)
L2_w8_1:
    s_waitcnt vmcnt(1)
L2_w8_2:
    s_waitcnt vmcnt(2)
L2_w8_3:
    s_waitcnt vmcnt(3)
L2_w8_4:
    s_waitcnt vmcnt(4)
L2_w8_5:
    s_waitcnt vmcnt(5)
L2_w8_6:
    s_waitcnt vmcnt(6)
L2_w8_7:
    s_waitcnt vmcnt(7)
L2_w8_8:
    s_waitcnt vmcnt(8)
    s_add_u32 s41, s41, 1
    s_cmp_ge_u32 s41, 4
    s_cbranch_scc0 L2_pr4
    s_setprio 2
    s_cmp_ge_u32 s41, 6
    s_cbranch_scc0 L2_pr4
    s_setprio 1
    s_cmp_ge_u32 s41, 8
    s_cbranch_scc0 L2_pr4
    s_setprio 0
L2_pr4:
L2_g5:
    ds_read_b128 v[240:243], v253 offset:26272
    ds_read_b128 v[244:247], v253 offset:26288
    ds_read_b128 v[232:235], v248 offset:720
    s_cmp_gt_u32 s39, 6
    s_cbranch_scc1 L2_v4_5
    s_cmp_gt_u32 s39, 4
    s_cbranch_scc1 L2_v3_5
    s_cmp_eq_u32 s39, 0
    s_cbranch_scc1 L2_skip5
    v_perm_b32 v224, v196, v192, s18
    v_perm_b32 v225, v204, v200, s18
    v_perm_b32 v228, v196, v192, s19
    v_perm_b32 v229, v204, v200, s19
    v_mfma_f32_16x16x16_bf16 v[0:3], v[236:237], v[224:225], v[0:3]
    v_perm_b32 v224, v197, v193, s18
    v_perm_b32 v225, v205, v201, s18
    v_mfma_f32_16x16x16_bf16 v[4:7], v[236:237], v[228:229], v[4:7]
    v_perm_b32 v228, v197, v193, s19
    v_perm_b32 v229, v205, v201, s19
    v_mfma_f32_16x16x16_bf16 v[8:11], v[236:237], v[224:225], v[8:11]
    v_perm_b32 v224, v198, v194, s18
    v_perm_b32 v225, v206, v202, s18
    v_mfma_f32_16x16x16_bf16 v[12:15], v[236:237], v[228:229], v[12:15]
    v_perm_b32 v228, v198, v194, s19
    v_perm_b32 v229, v206, v202, s19
    v_mfma_f32_16x16x16_bf16 v[16:19], v[236:237], v[224:225], v[16:19]
    v_perm_b32 v224, v199, v195, s18
    v_perm_b32 v225, v207, v203, s18
    v_mfma_f32_16x16x16_bf16 v[20:23], v[236:237], v[228:229], v[20:23]
    v_perm_b32 v228, v199, v195, s19
    v_perm_b32 v229, v207, v203, s19
    v_mfma_f32_16x16x16_bf16 v[24:27], v[236:237], v[224:225], v[24:27]
    s_nop 0
    v_mfma_f32_16x16x16_bf16 v[28:31], v[236:237], v[228:229], v[28:31]
    s_branch L2_skip5
L2_v3_5:
    v_perm_b32 v224, v196, v192, s18
    v_perm_b32 v225, v204, v200, s18
    v_perm_b32 v226, v212, v208, s18
    v_perm_b32 v228, v196, v192, s19
    v_perm_b32 v229, v204, v200, s19
    v_perm_b32 v230, v212, v208, s19
    v_mfma_f32_16x16x32_bf16 v[0:3], v[236:239], v[224:227], v[0:3]
    v_perm_b32 v224, v197, v193, s18
    v_perm_b32 v225, v205, v201, s18
    v_perm_b32 v226, v213, v209, s18
    v_mfma_f32_16x16x32_bf16 v[4:7], v[236:239], v[228:231], v[4:7]
    v_perm_b32 v228, v197, v193, s19
    v_perm_b32 v229, v205, v201, s19
    v_perm_b32 v230, v213, v209, s19
    v_mfma_f32_16x16x32_bf16 v[8:11], v[236:239], v[224:227], v[8:11]
    v_perm_b32 v224, v198, v194, s18
    v_perm_b32 v225, v206, v202, s18
    v_perm_b32 v226, v214, v210, s18
    v_mfma_f32_16x16x32_bf16 v[12:15], v[236:239], v[228:231], v[12:15]
    v_perm_b32 v228, v198, v194, s19
    v_perm_b32 v229, v206, v202, s19
    v_perm_b32 v230, v214, v210, s19
    v_mfma_f32_16x16x32_bf16 v[16:19], v[236:239], v[224:227], v[16:19]
    v_perm_b32 v224, v199, v195, s18
    v_perm_b32 v225, v207, v203, s18
    v_perm_b32 v226, v215, v211, s18
    v_mfma_f32_16x16x32_bf16 v[20:23], v[236:239], v[228:231], v[20:23]
    v_perm_b32 v228, v199, v195, s19
    v_perm_b32 v229, v207, v203, s19
    v_perm_b32 v230, v215, v211, s19
    v_mfma_f32_16x16x32_bf16 v[24:27], v[236:239], v[224:227], v[24:27]
    s_nop 0
    v_mfma_f32_16x16x32_bf16 v[28:31], v[236:239], v[228:231], v[28:31]
    s_branch L2_skip5
L2_v4_5:
    v_perm_b32 v224, v196, v192, s18
    v_perm_b32 v225, v204, v200, s18
    v_perm_b32 v226, v212, v208, s18
    v_perm_b32 v227, v220, v216, s18
    v_perm_b32 v228, v196, v192, s19
    v_perm_b32 v229, v204, v200, s19
    v_perm_b32 v230, v212, v208, s19
    v_perm_b32 v231, v220, v216, s19
    v_mfma_f32_16x16x32_bf16 v[0:3], v[236:239], v[224:227], v[0:3]
    v_perm_b32 v224, v197, v193, s18
    v_perm_b32 v225, v205, v201, s18
    v_perm_b32 v226, v213, v209, s18
    v_perm_b32 v227, v221, v217, s18
    v_mfma_f32_16x16x32_bf16 v[4:7], v[236:239], v[228:231], v[4:7]
    v_perm_b32 v228, v197, v193, s19
    v_perm_b32 v229, v205, v201, s19
    v_perm_b32 v230, v213, v209, s19
    v_perm_b32 v231, v221, v217, s19
    v_mfma_f32_16x16x32_bf16 v[8:11], v[236:239], v[224:227], v[8:11]
    v_perm_b32 v224, v198, v194, s18
    v_perm_b32 v225, v206, v202, s18
    v_perm_b32 v226, v214, v210, s18
    v_perm_b32 v227, v222, v218, s18
    v_mfma_f32_16x16x32_bf16 v[12:15], v[236:239], v[228:231], v[12:15]
    v_perm_b32 v228, v198, v194, s19
    v_perm_b32 v229, v206, v202, s19
    v_perm_b32 v230, v214, v210, s19
    v_perm_b32 v231, v222, v218, s19
    v_mfma_f32_16x16x32_bf16 v[16:19], v[236:239], v[224:227], v[16:19]
    v_perm_b32 v224, v199, v195, s18
    v_perm_b32 v225, v207, v203, s18
    v_perm_b32 v226, v215, v211, s18
    v_perm_b32 v227, v223, v219, s18
    v_mfma_f32_16x16x32_bf16 v[20:23], v[236:239], v[228:231], v[20:23]
    v_perm_b32 v228, v199, v195, s19
    v_perm_b32 v229, v207, v203, s19
    v_perm_b32 v230, v215, v211, s19
    v_perm_b32 v231, v223, v219, s19
    v_mfma_f32_16x16x32_bf16 v[24:27], v[236:239], v[224:227], v[24:27]
    s_nop 0
    v_mfma_f32_16x16x32_bf16 v[28:31], v[236:239], v[228:231], v[28:31]
L2_skip5:
    s_cmp_eq_u32 s40, s50
    s_cbranch_scc1 L2_x0
    s_and_b32 s39, s32, 0xff
    s_bcnt1_i32_b32 s39, s39
    s_lshr_b64 s[32:33], s[32:33], 8
    s_waitcnt lgkmcnt(0)
    s_cmp_le_u32 s39, 0
    s_cbranch_scc1 L2_w9_0
    buffer_load_dwordx4 v[192:195], v240, s[8:11], 0 offen
    s_cmp_le_u32 s39, 1
    s_cbranch_scc1 L2_w9_1
    buffer_load_dwordx4 v[196:199], v241, s[8:11], 0 offen
    s_cmp_le_u32 s39, 2
    s_cbranch_scc1 L2_w9_2
    buffer_load_dwordx4 v[200:203], v242, s[8:11], 0 offen
    s_cmp_le_u32 s39, 3
    s_cbranch_scc1 L2_w9_3
    buffer_load_dwordx4 v[204:207], v243, s[8:11], 0 offen
    s_cmp_le_u32 s39, 4
    s_cbranch_scc1 L2_w9_4
    buffer_load_dwordx4 v[208:211], v244, s[8:11], 0 offen
    s_cmp_le_u32 s39, 5
    s_cbranch_scc1 L2_w9_5
    buffer_load_dwordx4 v[212:215], v245, s[8:11], 0 offen
    s_cmp_le_u32 s39, 6
    s_cbranch_scc1 L2_w9_6
    buffer_load_dwordx4 v[216:219], v246, s[8:11], 0 offen
    s_cmp_le_u32 s39, 7
    s_cbranch_scc1 L2_w9_7
    buffer_load_dwordx4 v[220:223], v247, s[8:11], 0 offen
    s_branch L2_w9_8
L2_w9_0:
    s_waitcnt vmcnt(0)
L2_w9_1:
    s_waitcnt vmcnt(1)
L2_w9_2:
    s_waitcnt vmcnt(2)
L2_w9_3:
    s_waitcnt vmcnt(3)
L2_w9_4:
    s_waitcnt vmcnt(4)
L2_w9_5:
    s_waitcnt vmcnt(5)
L2_w9_6:
    s_waitcnt vmcnt(6)
L2_w9_7:
    s_waitcnt vmcnt(7)
L2_w9_8:
    s_waitcnt vmcnt(8)
L2_g6:
    ds_read_b128 v[240:243], v253 offset:26528
    ds_read_b128 v[244:247], v253 offset:26544
    ds_read_b128 v[236:239], v248 offset:1360
    s_cmp_gt_u32 s38, 6
    s_cbranch_scc1 L2_v4_6
    s_cmp_gt_u32 s38, 4
    s_cbranch_scc1 L2_v3_6
    s_cmp_eq_u32 s38, 0
    s_cbranch_scc1 L2_skip6
    v_perm_b32 v224, v164, v160, s18
    v_perm_b32 v225, v172, v168, s18
    v_perm_b32 v228, v164, v160, s19
    v_perm_b32 v229, v172, v168, s19
    v_mfma_f32_16x16x16_bf16 v[32:35], v[232:233], v[224:225], v[32:35]
    v_perm_b32 v224, v165, v161, s18
    v_perm_b32 v225, v173, v169, s18
    v_mfma_f32_16x16x16_bf16 v[36:39], v[232:233], v[228:229], v[36:39]
    v_perm_b32 v228, v165, v161, s19
    v_perm_b32 v229, v173, v169, s19
    v_mfma_f32_16x16x16_bf16 v[40:43], v[232:233], v[224:225], v[40:43]
    v_perm_b32 v224, v166, v162, s18
    v_perm_b32 v225, v174, v170, s18
    v_mfma_f32_16x16x16_bf16 v[44:47], v[232:233], v[228:229], v[44:47]
    v_perm_b32 v228, v166, v162, s19
    v_perm_b32 v229, v174, v170, s19
    v_mfma_f32_16x16x16_bf16 v[48:51], v[232:233], v[224:225], v[48:51]
    v_perm_b32 v224, v167, v163, s18
    v_perm_b32 v225, v175, v171, s18
    v_mfma_f32_16x16x16_bf16 v[52:55], v[232:233], v[228:229], v[52:55]
    v_perm_b32 v228, v167, v163, s19
    v_perm_b32 v229, v175, v171, s19
    v_mfma_f32_16x16x16_bf16 v[56:59], v[232:233], v[224:225], v[56:59]
    s_nop 0
    v_mfma_f32_16x16x16_bf16 v[60:63], v[232:233], v[228:229], v[60:63]
    s_branch L2_skip6
L2_v3_6:
    v_perm_b32 v224, v164, v160, s18
    v_perm_b32 v225, v172, v168, s18
    v_perm_b32 v226, v180, v176, s18
    v_perm_b32 v228, v164, v160, s19
    v_perm_b32 v229, v172, v168, s19
    v_perm_b32 v230, v180, v176, s19
    v_mfma_f32_16x16x32_bf16 v[32:35], v[232:235], v[224:227], v[32:35]
    v_perm_b32 v224, v165, v161, s18
    v_perm_b32 v225, v173, v169, s18
    v_perm_b32 v226, v181, v177, s18
    v_mfma_f32_16x16x32_bf16 v[36:39], v[232:235], v[228:231], v[36:39]
    v_perm_b32 v228, v165, v161, s19
    v_perm_b32 v229, v173, v169, s19
    v_perm_b32 v230, v181, v177, s19
    v_mfma_f32_16x16x32_bf16 v[40:43], v[232:235], v[224:227], v[40:43]
    v_perm_b32 v224, v166, v162, s18
    v_perm_b32 v225, v174, v170, s18
    v_perm_b32 v226, v182, v178, s18
    v_mfma_f32_16x16x32_bf16 v[44:47], v[232:235], v[228:231], v[44:47]
    v_perm_b32 v228, v166, v162, s19
    v_perm_b32 v229, v174, v170, s19
    v_perm_b32 v230, v182, v178, s19
    v_mfma_f32_16x16x32_bf16 v[48:51], v[232:235], v[224:227], v[48:51]
    v_perm_b32 v224, v167, v163, s18
    v_perm_b32 v225, v175, v171, s18
    v_perm_b32 v226, v183, v179, s18
    v_mfma_f32_16x16x32_bf16 v[52:55], v[232:235], v[228:231], v[52:55]
    v_perm_b32 v228, v167, v163, s19
    v_perm_b32 v229, v175, v171, s19
    v_perm_b32 v230, v183, v179, s19
    v_mfma_f32_16x16x32_bf16 v[56:59], v[232:235], v[224:227], v[56:59]
    s_nop 0
    v_mfma_f32_16x16x32_bf16 v[60:63], v[232:235], v[228:231], v[60:63]
    s_branch L2_skip6
L2_v4_6:
    v_perm_b32 v224, v164, v160, s18
    v_perm_b32 v225, v172, v168, s18
    v_perm_b32 v226, v180, v176, s18
    v_perm_b32 v227, v188, v184, s18
    v_perm_b32 v228, v164, v160, s19
    v_perm_b32 v229, v172, v168, s19
    v_perm_b32 v230, v180, v176, s19
    v_perm_b32 v231, v188, v184, s19
    v_mfma_f32_16x16x32_bf16 v[32:35], v[232:235], v[224:227], v[32:35]
    v_perm_b32 v224, v165, v161, s18
    v_perm_b32 v225, v173, v169, s18
    v_perm_b32 v226, v181, v177, s18
    v_perm_b32 v227, v189, v185, s18
    v_mfma_f32_16x16x32_bf16 v[36:39], v[232:235], v[228:231], v[36:39]
    v_perm_b32 v228, v165, v161, s19
    v_perm_b32 v229, v173, v169, s19
    v_perm_b32 v230, v181, v177, s19
    v_perm_b32 v231, v189, v185, s19
    v_mfma_f32_16x16x32_bf16 v[40:43], v[232:235], v[224:227], v[40:43]
    v_perm_b32 v224, v166, v162, s18
    v_perm_b32 v225, v174, v170, s18
    v_perm_b32 v226, v182, v178, s18
    v_perm_b32 v227, v190, v186, s18
    v_mfma_f32_16x16x32_bf16 v[44:47], v[232:235], v[228:231], v[44:47]
    v_perm_b32 v228, v166, v162, s19
    v_perm_b32 v229, v174, v170, s19
    v_perm_b32 v230, v182, v178, s19
    v_perm_b32 v231, v190, v186, s19
    v_mfma_f32_16x16x32_bf16 v[48:51], v[232:235], v[224:227], v[48:51]
    v_perm_b32 v224, v167, v163, s18
    v_perm_b32 v225, v175, v171, s18
    v_perm_b32 v226, v183, v179, s18
    v_perm_b32 v227, v191, v187, s18
    v_mfma_f32_16x16x32_bf16 v[52:55], v[232:235], v[228:231], v[52:55]
    v_perm_b32 v228, v167, v163, s19
    v_perm_b32 v229, v175, v171, s19
    v_perm_b32 v230, v183, v179, s19
    v_perm_b32 v231, v191, v187, s19
    v_mfma_f32_16x16x32_bf16 v[56:59], v[232:235], v[224:227], v[56:59]
    s_nop 0
    v_mfma_f32_16x16x32_bf16 v[60:63], v[232:235], v[228:231], v[60:63]
L2_skip6:
    s_cmp_eq_u32 s40, s50
    s_cbranch_scc1 L2_x1
    s_and_b32 s38, s34, 0xff
    s_bcnt1_i32_b32 s38, s38
    s_lshr_b64 s[34:35], s[34:35], 8
    s_waitcnt lgkmcnt(0)
    s_cmp_le_u32 s38, 0
    s_cbranch_scc1 L2_w10_0
    buffer_load_dwordx4 v[160:163], v240, s[8:11], 0 offen
    s_cmp_le_u32 s38, 1
    s_cbranch_scc1 L2_w10_1
    buffer_load_dwordx4 v[164:167], v241, s[8:11], 0 offen
    s_cmp_le_u32 s38, 2
    s_cbranch_scc1 L2_w10_2
    buffer_load_dwordx4 v[168:171], v242, s[8:11], 0 offen
    s_cmp_le_u32 s38, 3
    s_cbranch_scc1 L2_w10_3
    buffer_load_dwordx4 v[172:175], v243, s[8:11], 0 offen
    s_cmp_le_u32 s38, 4
    s_cbranch_scc1 L2_w10_4
    buffer_load_dwordx4 v[176:179], v244, s[8:11], 0 offen
    s_cmp_le_u32 s38, 5
    s_cbranch_scc1 L2_w10_5
    buffer_load_dwordx4 v[180:183], v245, s[8:11], 0 offen
    s_cmp_le_u32 s38, 6
    s_cbranch_scc1 L2_w10_6
    buffer_load_dwordx4 v[184:187], v246, s[8:11], 0 offen
    s_cmp_le_u32 s38, 7
    s_cbranch_scc1 L2_w10_7
    buffer_load_dwordx4 v[188:191], v247, s[8:11], 0 offen
    s_branch L2_w10_8
L2_w10_0:
    s_waitcnt vmcnt(0)
L2_w10_1:
    s_waitcnt vmcnt(1)
L2_w10_2:
    s_waitcnt vmcnt(2)
L2_w10_3:
    s_waitcnt vmcnt(3)
L2_w10_4:
    s_waitcnt vmcnt(4)
L2_w10_5:
    s_waitcnt vmcnt(5)
L2_w10_6:
    s_waitcnt vmcnt(6)
L2_w10_7:
    s_waitcnt vmcnt(7)
L2_w10_8:
    s_waitcnt vmcnt(8)
L2_g7:
    ds_read_b128 v[240:243], v253 offset:26784
    ds_read_b128 v[244:247], v253 offset:26800
    ds_read_b128 v[232:235], v248 offset:2000
    s_cmp_gt_u32 s39, 6
    s_cbranch_scc1 L2_v4_7
    s_cmp_gt_u32 s39, 4
    s_cbranch_scc1 L2_v3_7
    s_cmp_eq_u32 s39, 0
    s_cbranch_scc1 L2_skip7
    v_perm_b32 v224, v196, v192, s18
    v_perm_b32 v225, v204, v200, s18
    v_perm_b32 v228, v196, v192, s19
    v_perm_b32 v229, v204, v200, s19
    v_mfma_f32_16x16x16_bf16 v[64:67], v[236:237], v[224:225], v[64:67]
    v_perm_b32 v224, v197, v193, s18
    v_perm_b32 v225, v205, v201, s18
    v_mfma_f32_16x16x16_bf16 v[68:71], v[236:237], v[228:229], v[68:71]
    v_perm_b32 v228, v197, v193, s19
    v_perm_b32 v229, v205, v201, s19
    v_mfma_f32_16x16x16_bf16 v[72:75], v[236:237], v[224:225], v[72:75]
    v_perm_b32 v224, v198, v194, s18
    v_perm_b32 v225, v206, v202, s18
    v_mfma_f32_16x16x16_bf16 v[76:79], v[236:237], v[228:229], v[76:79]
    v_perm_b32 v228, v198, v194, s19
    v_perm_b32 v229, v206, v202, s19
    v_mfma_f32_16x16x16_bf16 v[80:83], v[236:237], v[224:225], v[80:83]
    v_perm_b32 v224, v199, v195, s18
    v_perm_b32 v225, v207, v203, s18
    v_mfma_f32_16x16x16_bf16 v[84:87], v[236:237], v[228:229], v[84:87]
    v_perm_b32 v228, v199, v195, s19
    v_perm_b32 v229, v207, v203, s19
    v_mfma_f32_16x16x16_bf16 v[88:91], v[236:237], v[224:225], v[88:91]
    s_nop 0
    v_mfma_f32_16x16x16_bf16 v[92:95], v[236:237], v[228:229], v[92:95]
    s_branch L2_skip7
L2_v3_7:
    v_perm_b32 v224, v196, v192, s18
    v_perm_b32 v225, v204, v200, s18
    v_perm_b32 v226, v212, v208, s18
    v_perm_b32 v228, v196, v192, s19
    v_perm_b32 v229, v204, v200, s19
    v_perm_b32 v230, v212, v208, s19
    v_mfma_f32_16x16x32_bf16 v[64:67], v[236:239], v[224:227], v[64:67]
    v_perm_b32 v224, v197, v193, s18
    v_perm_b32 v225, v205, v201, s18
    v_perm_b32 v226, v213, v209, s18
    v_mfma_f32_16x16x32_bf16 v[68:71], v[236:239], v[228:231], v[68:71]
    v_perm_b32 v228, v197, v193, s19
    v_perm_b32 v229, v205, v201, s19
    v_perm_b32 v230, v213, v209, s19
    v_mfma_f32_16x16x32_bf16 v[72:75], v[236:239], v[224:227], v[72:75]
    v_perm_b32 v224, v198, v194, s18
    v_perm_b32 v225, v206, v202, s18
    v_perm_b32 v226, v214, v210, s18
    v_mfma_f32_16x16x32_bf16 v[76:79], v[236:239], v[228:231], v[76:79]
    v_perm_b32 v228, v198, v194, s19
    v_perm_b32 v229, v206, v202, s19
    v_perm_b32 v230, v214, v210, s19
    v_mfma_f32_16x16x32_bf16 v[80:83], v[236:239], v[224:227], v[80:83]
    v_perm_b32 v224, v199, v195, s18
    v_perm_b32 v225, v207, v203, s18
    v_perm_b32 v226, v215, v211, s18
    v_mfma_f32_16x16x32_bf16 v[84:87], v[236:239], v[228:231], v[84:87]
    v_perm_b32 v228, v199, v195, s19
    v_perm_b32 v229, v207, v203, s19
    v_perm_b32 v230, v215, v211, s19
    v_mfma_f32_16x16x32_bf16 v[88:91], v[236:239], v[224:227], v[88:91]
    s_nop 0
    v_mfma_f32_16x16x32_bf16 v[92:95], v[236:239], v[228:231], v[92:95]
    s_branch L2_skip7
L2_v4_7:
    v_perm_b32 v224, v196, v192, s18
    v_perm_b32 v225, v204, v200, s18
    v_perm_b32 v226, v212, v208, s18
    v_perm_b32 v227, v220, v216, s18
    v_perm_b32 v228, v196, v192, s19
    v_perm_b32 v229, v204, v200, s19
    v_perm_b32 v230, v212, v208, s19
    v_perm_b32 v231, v220, v216, s19
    v_mfma_f32_16x16x32_bf16 v[64:67], v[236:239], v[224:227], v[64:67]
    v_perm_b32 v224, v197, v193, s18
    v_perm_b32 v225, v205, v201, s18
    v_perm_b32 v226, v213, v209, s18
    v_perm_b32 v227, v221, v217, s18
    v_mfma_f32_16x16x32_bf16 v[68:71], v[236:239], v[228:231], v[68:71]
    v_perm_b32 v228, v197, v193, s19
    v_perm_b32 v229, v205, v201, s19
    v_perm_b32 v230, v213, v209, s19
    v_perm_b32 v231, v221, v217, s19
    v_mfma_f32_16x16x32_bf16 v[72:75], v[236:239], v[224:227], v[72:75]
    v_perm_b32 v224, v198, v194, s18
    v_perm_b32 v225, v206, v202, s18
    v_perm_b32 v226, v214, v210, s18
    v_perm_b32 v227, v222, v218, s18
    v_mfma_f32_16x16x32_bf16 v[76:79], v[236:239], v[228:231], v[76:79]
    v_perm_b32 v228, v198, v194, s19
    v_perm_b32 v229, v206, v202, s19
    v_perm_b32 v230, v214, v210, s19
    v_perm_b32 v231, v222, v218, s19
    v_mfma_f32_16x16x32_bf16 v[80:83], v[236:239], v[224:227], v[80:83]
    v_perm_b32 v224, v199, v195, s18
    v_perm_b32 v225, v207, v203, s18
    v_perm_b32 v226, v215, v211, s18
    v_perm_b32 v227, v223, v219, s18
    v_mfma_f32_16x16x32_bf16 v[84:87], v[236:239], v[228:231], v[84:87]
    v_perm_b32 v228, v199, v195, s19
    v_perm_b32 v229, v207, v203, s19
    v_perm_b32 v230, v215, v211, s19
    v_perm_b32 v231, v223, v219, s19
    v_mfma_f32_16x16x32_bf16 v[88:91], v[236:239], v[224:227], v[88:91]
    s_nop 0
    v_mfma_f32_16x16x32_bf16 v[92:95], v[236:239], v[228:231], v[92:95]
L2_skip7:
    s_cmp_eq_u32 s40, s50
    s_cbranch_scc1 L2_x2
    s_and_b32 s39, s36, 0xff
    s_bcnt1_i32_b32 s39, s39
    s_lshr_b64 s[36:37], s[36:37], 8
    s_waitcnt lgkmcnt(0)
    s_cmp_le_u32 s39, 0
    s_cbranch_scc1 L2_w11_0
    buffer_load_dwordx4 v[192:195], v240, s[8:11], 0 offen
    s_cmp_le_u32 s39, 1
    s_cbranch_scc1 L2_w11_1
    buffer_load_dwordx4 v[196:199], v241, s[8:11], 0 offen
    s_cmp_le_u32 s39, 2
    s_cbranch_scc1 L2_w11_2
    buffer_load_dwordx4 v[200:203], v242, s[8:11], 0 offen
    s_cmp_le_u32 s39, 3
    s_cbranch_scc1 L2_w11_3
    buffer_load_dwordx4 v[204:207], v243, s[8:11], 0 offen
    s_cmp_le_u32 s39, 4
    s_cbranch_scc1 L2_w11_4
    buffer_load_dwordx4 v[208:211], v244, s[8:11], 0 offen
    s_cmp_le_u32 s39, 5
    s_cbranch_scc1 L2_w11_5
    buffer_load_dwordx4 v[212:215], v245, s[8:11], 0 offen
    s_cmp_le_u32 s39, 6
    s_cbranch_scc1 L2_w11_6
    buffer_load_dwordx4 v[216:219], v246, s[8:11], 0 offen
    s_cmp_le_u32 s39, 7
    s_cbranch_scc1 L2_w11_7
    buffer_load_dwordx4 v[220:223], v247, s[8:11], 0 offen
    s_branch L2_w11_8
L2_w11_0:
    s_waitcnt vmcnt(0)
L2_w11_1:
    s_waitcnt vmcnt(1)
L2_w11_2:
    s_waitcnt vmcnt(2)
L2_w11_3:
    s_waitcnt vmcnt(3)
L2_w11_4:
    s_waitcnt vmcnt(4)
L2_w11_5:
    s_waitcnt vmcnt(5)
L2_w11_6:
    s_waitcnt vmcnt(6)
L2_w11_7:
    s_waitcnt vmcnt(7)
L2_w11_8:
    s_waitcnt vmcnt(8)
L2_g8:
    ds_read_b128 v[240:243], v253 offset:25792
    ds_read_b128 v[244:247], v253 offset:25808
    ds_read_b128 v[236:239], v248 offset:2640
    s_cmp_gt_u32 s38, 6
    s_cbranch_scc1 L2_v4_8
    s_cmp_gt_u32 s38, 4
    s_cbranch_scc1 L2_v3_8
    s_cmp_eq_u32 s38, 0
    s_cbranch_scc1 L2_skip8
    v_perm_b32 v224, v164, v160, s18
    v_perm_b32 v225, v172, v168, s18
    v_perm_b32 v228, v164, v160, s19
    v_perm_b32 v229, v172, v168, s19
    v_mfma_f32_16x16x16_bf16 v[96:99], v[232:233], v[224:225], v[96:99]
    v_perm_b32 v224, v165, v161, s18
    v_perm_b32 v225, v173, v169, s18
    v_mfma_f32_16x16x16_bf16 v[100:103], v[232:233], v[228:229], v[100:103]
    v_perm_b32 v228, v165, v161, s19
    v_perm_b32 v229, v173, v169, s19
    v_mfma_f32_16x16x16_bf16 v[104:107], v[232:233], v[224:225], v[104:107]
    v_perm_b32 v224, v166, v162, s18
    v_perm_b32 v225, v174, v170, s18
    v_mfma_f32_16x16x16_bf16 v[108:111], v[232:233], v[228:229], v[108:111]
    v_perm_b32 v228, v166, v162, s19
    v_perm_b32 v229, v174, v170, s19
    v_mfma_f32_16x16x16_bf16 v[112:115], v[232:233], v[224:225], v[112:115]
    v_perm_b32 v224, v167, v163, s18
    v_perm_b32 v225, v175, v171, s18
    v_mfma_f32_16x16x16_bf16 v[116:119], v[232:233], v[228:229], v[116:119]
    v_perm_b32 v228, v167, v163, s19
    v_perm_b32 v229, v175, v171, s19
    v_mfma_f32_16x16x16_bf16 v[120:123], v[232:233], v[224:225], v[120:123]
    s_nop 0
    v_mfma_f32_16x16x16_bf16 v[124:127], v[232:233], v[228:229], v[124:127]
    s_branch L2_skip8
L2_v3_8:
    v_perm_b32 v224, v164, v160, s18
    v_perm_b32 v225, v172, v168, s18
    v_perm_b32 v226, v180, v176, s18
    v_perm_b32 v228, v164, v160, s19
    v_perm_b32 v229, v172, v168, s19
    v_perm_b32 v230, v180, v176, s19
    v_mfma_f32_16x16x32_bf16 v[96:99], v[232:235], v[224:227], v[96:99]
    v_perm_b32 v224, v165, v161, s18
    v_perm_b32 v225, v173, v169, s18
    v_perm_b32 v226, v181, v177, s18
    v_mfma_f32_16x16x32_bf16 v[100:103], v[232:235], v[228:231], v[100:103]
    v_perm_b32 v228, v165, v161, s19
    v_perm_b32 v229, v173, v169, s19
    v_perm_b32 v230, v181, v177, s19
    v_mfma_f32_16x16x32_bf16 v[104:107], v[232:235], v[224:227], v[104:107]
    v_perm_b32 v224, v166, v162, s18
    v_perm_b32 v225, v174, v170, s18
    v_perm_b32 v226, v182, v178, s18
    v_mfma_f32_16x16x32_bf16 v[108:111], v[232:235], v[228:231], v[108:111]
    v_perm_b32 v228, v166, v162, s19
    v_perm_b32 v229, v174, v170, s19
    v_perm_b32 v230, v182, v178, s19
    v_mfma_f32_16x16x32_bf16 v[112:115], v[232:235], v[224:227], v[112:115]
    v_perm_b32 v224, v167, v163, s18
    v_perm_b32 v225, v175, v171, s18
    v_perm_b32 v226, v183, v179, s18
    v_mfma_f32_16x16x32_bf16 v[116:119], v[232:235], v[228:231], v[116:119]
    v_perm_b32 v228, v167, v163, s19
    v_perm_b32 v229, v175, v171, s19
    v_perm_b32 v230, v183, v179, s19
    v_mfma_f32_16x16x32_bf16 v[120:123], v[232:235], v[224:227], v[120:123]
    s_nop 0
    v_mfma_f32_16x16x32_bf16 v[124:127], v[232:235], v[228:231], v[124:127]
    s_branch L2_skip8
L2_v4_8:
    v_perm_b32 v224, v164, v160, s18
    v_perm_b32 v225, v172, v168, s18
    v_perm_b32 v226, v180, v176, s18
    v_perm_b32 v227, v188, v184, s18
    v_perm_b32 v228, v164, v160, s19
    v_perm_b32 v229, v172, v168, s19
    v_perm_b32 v230, v180, v176, s19
    v_perm_b32 v231, v188, v184, s19
    v_mfma_f32_16x16x32_bf16 v[96:99], v[232:235], v[224:227], v[96:99]
    v_perm_b32 v224, v165, v161, s18
    v_perm_b32 v225, v173, v169, s18
    v_perm_b32 v226, v181, v177, s18
    v_perm_b32 v227, v189, v185, s18
    v_mfma_f32_16x16x32_bf16 v[100:103], v[232:235], v[228:231], v[100:103]
    v_perm_b32 v228, v165, v161, s19
    v_perm_b32 v229, v173, v169, s19
    v_perm_b32 v230, v181, v177, s19
    v_perm_b32 v231, v189, v185, s19
    v_mfma_f32_16x16x32_bf16 v[104:107], v[232:235], v[224:227], v[104:107]
    v_perm_b32 v224, v166, v162, s18
    v_perm_b32 v225, v174, v170, s18
    v_perm_b32 v226, v182, v178, s18
    v_perm_b32 v227, v190, v186, s18
    v_mfma_f32_16x16x32_bf16 v[108:111], v[232:235], v[228:231], v[108:111]
    v_perm_b32 v228, v166, v162, s19
    v_perm_b32 v229, v174, v170, s19
    v_perm_b32 v230, v182, v178, s19
    v_perm_b32 v231, v190, v186, s19
    v_mfma_f32_16x16x32_bf16 v[112:115], v[232:235], v[224:227], v[112:115]
    v_perm_b32 v224, v167, v163, s18
    v_perm_b32 v225, v175, v171, s18
    v_perm_b32 v226, v183, v179, s18
    v_perm_b32 v227, v191, v187, s18
    v_mfma_f32_16x16x32_bf16 v[116:119], v[232:235], v[228:231], v[116:119]
    v_perm_b32 v228, v167, v163, s19
    v_perm_b32 v229, v175, v171, s19
    v_perm_b32 v230, v183, v179, s19
    v_perm_b32 v231, v191, v187, s19
    v_mfma_f32_16x16x32_bf16 v[120:123], v[232:235], v[224:227], v[120:123]
    s_nop 0
    v_mfma_f32_16x16x32_bf16 v[124:127], v[232:235], v[228:231], v[124:127]
L2_skip8:
    s_cmp_eq_u32 s40, s50
    s_cbranch_scc1 L2_x3
    s_and_b32 s38, s28, 0xff
    s_bcnt1_i32_b32 s38, s38
    s_lshr_b64 s[28:29], s[28:29], 8
    s_waitcnt lgkmcnt(0)
    s_cmp_le_u32 s38, 0
    s_cbranch_scc1 L2_w12_0
    buffer_load_dwordx4 v[160:163], v240, s[8:11], 0 offen
    s_cmp_le_u32 s38, 1
    s_cbranch_scc1 L2_w12_1
    buffer_load_dwordx4 v[164:167], v241, s[8:11], 0 offen
    s_cmp_le_u32 s38, 2
    s_cbranch_scc1 L2_w12_2
    buffer_load_dwordx4 v[168:171], v242, s[8:11], 0 offen
    s_cmp_le_u32 s38, 3
    s_cbranch_scc1 L2_w12_3
    buffer_load_dwordx4 v[172:175], v243, s[8:11], 0 offen
    s_cmp_le_u32 s38, 4
    s_cbranch_scc1 L2_w12_4
    buffer_load_dwordx4 v[176:179], v244, s[8:11], 0 offen
    s_cmp_le_u32 s38, 5
    s_cbranch_scc1 L2_w12_5
    buffer_load_dwordx4 v[180:183], v245, s[8:11], 0 offen
    s_cmp_le_u32 s38, 6
    s_cbranch_scc1 L2_w12_6
    buffer_load_dwordx4 v[184:187], v246, s[8:11], 0 offen
    s_cmp_le_u32 s38, 7
    s_cbranch_scc1 L2_w12_7
    buffer_load_dwordx4 v[188:191], v247, s[8:11], 0 offen
    s_branch L2_w12_8
L2_w12_0:
    s_waitcnt vmcnt(0)
L2_w12_1:
    s_waitcnt vmcnt(1)
L2_w12_2:
    s_waitcnt vmcnt(2)
L2_w12_3:
    s_waitcnt vmcnt(3)
L2_w12_4:
    s_waitcnt vmcnt(4)
L2_w12_5:
    s_waitcnt vmcnt(5)
L2_w12_6:
    s_waitcnt vmcnt(6)
L2_w12_7:
    s_waitcnt vmcnt(7)
L2_w12_8:
    s_waitcnt vmcnt(8)
L2_g9:
    ds_read_b128 v[240:243], v253 offset:26048
    ds_read_b128 v[244:247], v253 offset:26064
    ds_read_b128 v[232:235], v248 offset:160
    s_cmp_gt_u32 s39, 6
    s_cbranch_scc1 L2_v4_9
    s_cmp_gt_u32 s39, 4
    s_cbranch_scc1 L2_v3_9
    s_cmp_eq_u32 s39, 0
    s_cbranch_scc1 L2_skip9
    v_perm_b32 v224, v196, v192, s18
    v_perm_b32 v225, v204, v200, s18
    v_perm_b32 v228, v196, v192, s19
    v_perm_b32 v229, v204, v200, s19
    v_mfma_f32_16x16x16_bf16 v[128:131], v[236:237], v[224:225], v[128:131]
    v_perm_b32 v224, v197, v193, s18
    v_perm_b32 v225, v205, v201, s18
    v_mfma_f32_16x16x16_bf16 v[132:135], v[236:237], v[228:229], v[132:135]
    v_perm_b32 v228, v197, v193, s19
    v_perm_b32 v229, v205, v201, s19
    v_mfma_f32_16x16x16_bf16 v[136:139], v[236:237], v[224:225], v[136:139]
    v_perm_b32 v224, v198, v194, s18
    v_perm_b32 v225, v206, v202, s18
    v_mfma_f32_16x16x16_bf16 v[140:143], v[236:237], v[228:229], v[140:143]
    v_perm_b32 v228, v198, v194, s19
    v_perm_b32 v229, v206, v202, s19
    v_mfma_f32_16x16x16_bf16 v[144:147], v[236:237], v[224:225], v[144:147]
    v_perm_b32 v224, v199, v195, s18
    v_perm_b32 v225, v207, v203, s18
    v_mfma_f32_16x16x16_bf16 v[148:151], v[236:237], v[228:229], v[148:151]
    v_perm_b32 v228, v199, v195, s19
    v_perm_b32 v229, v207, v203, s19
    v_mfma_f32_16x16x16_bf16 v[152:155], v[236:237], v[224:225], v[152:155]
    s_nop 0
    v_mfma_f32_16x16x16_bf16 v[156:159], v[236:237], v[228:229], v[156:159]
    s_branch L2_skip9
L2_v3_9:
    v_perm_b32 v224, v196, v192, s18
    v_perm_b32 v225, v204, v200, s18
    v_perm_b32 v226, v212, v208, s18
    v_perm_b32 v228, v196, v192, s19
    v_perm_b32 v229, v204, v200, s19
    v_perm_b32 v230, v212, v208, s19
    v_mfma_f32_16x16x32_bf16 v[128:131], v[236:239], v[224:227], v[128:131]
    v_perm_b32 v224, v197, v193, s18
    v_perm_b32 v225, v205, v201, s18
    v_perm_b32 v226, v213, v209, s18
    v_mfma_f32_16x16x32_bf16 v[132:135], v[236:239], v[228:231], v[132:135]
    v_perm_b32 v228, v197, v193, s19
    v_perm_b32 v229, v205, v201, s19
    v_perm_b32 v230, v213, v209, s19
    v_mfma_f32_16x16x32_bf16 v[136:139], v[236:239], v[224:227], v[136:139]
    v_perm_b32 v224, v198, v194, s18
    v_perm_b32 v225, v206, v202, s18
    v_perm_b32 v226, v214, v210, s18
    v_mfma_f32_16x16x32_bf16 v[140:143], v[236:239], v[228:231], v[140:143]
    v_perm_b32 v228, v198, v194, s19
    v_perm_b32 v229, v206, v202, s19
    v_perm_b32 v230, v214, v210, s19
    v_mfma_f32_16x16x32_bf16 v[144:147], v[236:239], v[224:227], v[144:147]
    v_perm_b32 v224, v199, v195, s18
    v_perm_b32 v225, v207, v203, s18
    v_perm_b32 v226, v215, v211, s18
    v_mfma_f32_16x16x32_bf16 v[148:151], v[236:239], v[228:231], v[148:151]
    v_perm_b32 v228, v199, v195, s19
    v_perm_b32 v229, v207, v203, s19
    v_perm_b32 v230, v215, v211, s19
    v_mfma_f32_16x16x32_bf16 v[152:155], v[236:239], v[224:227], v[152:155]
    s_nop 0
    v_mfma_f32_16x16x32_bf16 v[156:159], v[236:239], v[228:231], v[156:159]
    s_branch L2_skip9
L2_v4_9:
    v_perm_b32 v224, v196, v192, s18
    v_perm_b32 v225, v204, v200, s18
    v_perm_b32 v226, v212, v208, s18
    v_perm_b32 v227, v220, v216, s18
    v_perm_b32 v228, v196, v192, s19
    v_perm_b32 v229, v204, v200, s19
    v_perm_b32 v230, v212, v208, s19
    v_perm_b32 v231, v220, v216, s19
    v_mfma_f32_16x16x32_bf16 v[128:131], v[236:239], v[224:227], v[128:131]
    v_perm_b32 v224, v197, v193, s18
    v_perm_b32 v225, v205, v201, s18
    v_perm_b32 v226, v213, v209, s18
    v_perm_b32 v227, v221, v217, s18
    v_mfma_f32_16x16x32_bf16 v[132:135], v[236:239], v[228:231], v[132:135]
    v_perm_b32 v228, v197, v193, s19
    v_perm_b32 v229, v205, v201, s19
    v_perm_b32 v230, v213, v209, s19
    v_perm_b32 v231, v221, v217, s19
    v_mfma_f32_16x16x32_bf16 v[136:139], v[236:239], v[224:227], v[136:139]
    v_perm_b32 v224, v198, v194, s18
    v_perm_b32 v225, v206, v202, s18
    v_perm_b32 v226, v214, v210, s18
    v_perm_b32 v227, v222, v218, s18
    v_mfma_f32_16x16x32_bf16 v[140:143], v[236:239], v[228:231], v[140:143]
    v_perm_b32 v228, v198, v194, s19
    v_perm_b32 v229, v206, v202, s19
    v_perm_b32 v230, v214, v210, s19
    v_perm_b32 v231, v222, v218, s19
    v_mfma_f32_16x16x32_bf16 v[144:147], v[236:239], v[224:227], v[144:147]
    v_perm_b32 v224, v199, v195, s18
    v_perm_b32 v225, v207, v203, s18
    v_perm_b32 v226, v215, v211, s18
    v_perm_b32 v227, v223, v219, s18
    v_mfma_f32_16x16x32_bf16 v[148:151], v[236:239], v[228:231], v[148:151]
    v_perm_b32 v228, v199, v195, s19
    v_perm_b32 v229, v207, v203, s19
    v_perm_b32 v230, v215, v211, s19
    v_perm_b32 v231, v223, v219, s19
    v_mfma_f32_16x16x32_bf16 v[152:155], v[236:239], v[224:227], v[152:155]
    s_nop 0
    v_mfma_f32_16x16x32_bf16 v[156:159], v[236:239], v[228:231], v[156:159]
L2_skip9:
    s_cmp_eq_u32 s40, s50
    s_cbranch_scc1 L2_x4
    s_and_b32 s39, s30, 0xff
    s_bcnt1_i32_b32 s39, s39
    s_lshr_b64 s[30:31], s[30:31], 8
    v_add_u32 v248, 160, v248
    v_add_u32 v253, 64, v253
    s_sub_u32 s40, s40, 1
    s_waitcnt lgkmcnt(0)
    s_cmp_le_u32 s39, 0
    s_cbranch_scc1 L2_w13_0
    buffer_load_dwordx4 v[192:195], v240, s[8:11], 0 offen
    s_cmp_le_u32 s39, 1
    s_cbranch_scc1 L2_w13_1
    buffer_load_dwordx4 v[196:199], v241, s[8:11], 0 offen
    s_cmp_le_u32 s39, 2
    s_cbranch_scc1 L2_w13_2
    buffer_load_dwordx4 v[200:203], v242, s[8:11], 0 offen
    s_cmp_le_u32 s39, 3
    s_cbranch_scc1 L2_w13_3
    buffer_load_dwordx4 v[204:207], v243, s[8:11], 0 offen
    s_cmp_le_u32 s39, 4
    s_cbranch_scc1 L2_w13_4
    buffer_load_dwordx4 v[208:211], v244, s[8:11], 0 offen
    s_cmp_le_u32 s39, 5
    s_cbranch_scc1 L2_w13_5
    buffer_load_dwordx4 v[212:215], v245, s[8:11], 0 offen
    s_cmp_le_u32 s39, 6
    s_cbranch_scc1 L2_w13_6
    buffer_load_dwordx4 v[216:219], v246, s[8:11], 0 offen
    s_cmp_le_u32 s39, 7
    s_cbranch_scc1 L2_w13_7
    buffer_load_dwordx4 v[220:223], v247, s[8:11], 0 offen
    s_branch L2_w13_8
L2_w13_0:
    s_waitcnt vmcnt(0)
L2_w13_1:
    s_waitcnt vmcnt(1)
L2_w13_2:
    s_waitcnt vmcnt(2)
L2_w13_3:
    s_waitcnt vmcnt(3)
L2_w13_4:
    s_waitcnt vmcnt(4)
L2_w13_5:
    s_waitcnt vmcnt(5)
L2_w13_6:
    s_waitcnt vmcnt(6)
L2_w13_7:
    s_waitcnt vmcnt(7)
L2_w13_8:
    s_waitcnt vmcnt(8)
    s_add_u32 s41, s41, 1
    s_cmp_ge_u32 s41, 4
    s_cbranch_scc0 L2_pr9
    s_setprio 2
    s_cmp_ge_u32 s41, 6
    s_cbranch_scc0 L2_pr9
    s_setprio 1
    s_cmp_ge_u32 s41, 8
    s_cbranch_scc0 L2_pr9
    s_setprio 0
L2_pr9:
    s_cmp_lg_u32 s40, 0
    s_cbranch_scc1 L2_sweep
    s_barrier
    v_mov_b32 v224, 0
    v_mov_b32 v225, 0
    v_mov_b32 v226, 0
    v_mov_b32 v227, 0
    v_mov_b32 v228, 0
    v_mov_b32 v229, 0
    v_mov_b32 v231, 0
    v_mov_b32 v230, -1
    v_and_b32 v232, 63, v252
    s_lshl_b32 s4, s17, 11
    s_add_u32 s4, s4, 41984
    v_lshl_add_u32 v232, v232, 4, s4
    v_add_u32 v235, 32768, v232
    v_lshlrev_b32 v233, 2, v252
    ds_write_b128 v232, v[228:231] offset:0
    ds_write_b128 v232, v[228:231] offset:16384
    ds_write_b128 v235, v[228:231] offset:0
    ds_write_b128 v235, v[228:231] offset:16384
    ds_write_b128 v235, v[228:231] offset:32768
    ds_write_b32 v233, v224 offset:37888
    s_waitcnt lgkmcnt(0)
    s_barrier
    s_cmp_lg_u32 s44, 0
    s_cbranch_scc1 L2_pass
    v_add_u32 v249, 320, v249
    v_add_u32 v250, -20, v250
    s_branch L2_batch
L2_pass:
    s_cmp_eq_u32 s60, 0
    s_cbranch_scc1 L2_pass1
    v_and_b32 v212, 127, v252
    s_lshr_b32 s4, s17, 1
    s_lshl_b32 s5, s4, 11
    s_add_u32 s5, s5, 123904
    v_lshl_add_u32 v253, v212, 2, s5
    s_add_u32 s40, s14, 4096
    s_addc_u32 s41, s15, 0
    ds_read_b32 v200, v253 offset:0
    ds_read_b32 v201, v253 offset:512
    ds_read_b32 v202, v253 offset:1024
    ds_read_b32 v203, v253 offset:1536
    s_waitcnt lgkmcnt(0)
    v_add_lshl_u32 v200, v200, v212, 4
    v_and_b32 v210, 1, v251
    v_cmp_ne_u32 s[20:21], 0, v210
    s_mov_b64 exec, s[20:21]
    s_cbranch_execz L2_pk0
    global_load_dwordx4 v[160:163], v200, s[14:15] offset:0 sc1
L2_pk0:
    s_mov_b64 exec, -1
    v_add_lshl_u32 v201, v201, v212, 4
    v_and_b32 v210, 2, v251
    v_cmp_ne_u32 s[22:23], 0, v210
    s_mov_b64 exec, s[22:23]
    s_cbranch_execz L2_pk1
    global_load_dwordx4 v[164:167], v201, s[14:15] offset:2048 sc1
L2_pk1:
    s_mov_b64 exec, -1
    v_add_lshl_u32 v202, v202, v212, 4
    v_and_b32 v210, 4, v251
    v_cmp_ne_u32 s[24:25], 0, v210
    s_mov_b64 exec, s[24:25]
    s_cbranch_execz L2_pk2
    global_load_dwordx4 v[168:171], v202, s[40:41] offset:0 sc1
L2_pk2:
    s_mov_b64 exec, -1
    v_add_lshl_u32 v203, v203, v212, 4
    v_and_b32 v210, 8, v251
    v_cmp_ne_u32 s[26:27], 0, v210
    s_mov_b64 exec, s[26:27]
    s_cbranch_execz L2_pk3
    global_load_dwordx4 v[172:175], v203, s[40:41] offset:2048 sc1
L2_pk3:
    s_mov_b64 exec, -1
    s_mov_b32 s42, 4
    s_branch L2_ld
L2_pass1:
    v_and_b32 v210, 1, v251
    v_cmp_ne_u32 s[20:21], 0, v210
    s_mov_b64 exec, s[20:21]
    global_load_dwordx4 v[160:163], v249, s[14:15] offset:0 sc1
    s_mov_b64 exec, -1
    v_and_b32 v210, 2, v251
    v_cmp_ne_u32 s[22:23], 0, v210
    s_mov_b64 exec, s[22:23]
    global_load_dwordx4 v[164:167], v249, s[14:15] offset:32 sc1
    s_mov_b64 exec, -1
    v_and_b32 v210, 4, v251
    v_cmp_ne_u32 s[24:25], 0, v210
    s_mov_b64 exec, s[24:25]
    global_load_dwordx4 v[168:171], v249, s[14:15] offset:64 sc1
    s_mov_b64 exec, -1
    v_and_b32 v210, 8, v251
    v_cmp_ne_u32 s[26:27], 0, v210
    s_mov_b64 exec, s[26:27]
    global_load_dwordx4 v[172:175], v249, s[14:15] offset:96 sc1
    s_mov_b64 exec, -1
    v_and_b32 v210, 16, v251
    v_cmp_ne_u32 s[28:29], 0, v210
    s_mov_b64 exec, s[28:29]
    global_load_dwordx4 v[176:179], v249, s[14:15] offset:128 sc1
    s_mov_b64 exec, -1
    v_and_b32 v210, 32, v251
    v_cmp_ne_u32 s[30:31], 0, v210
    s_mov_b64 exec, s[30:31]
    global_load_dwordx4 v[180:183], v249, s[14:15] offset:160 sc1
    s_mov_b64 exec, -1
    v_and_b32 v210, 64, v251
    v_cmp_ne_u32 s[32:33], 0, v210
    s_mov_b64 exec, s[32:33]
    global_load_dwordx4 v[184:187], v249, s[14:15] offset:192 sc1
    s_mov_b64 exec, -1
    v_and_b32 v210, 128, v251
    v_cmp_ne_u32 s[34:35], 0, v210
    s_mov_b64 exec, s[34:35]
    global_load_dwordx4 v[188:191], v249, s[14:15] offset:224 sc1
    s_mov_b64 exec, -1
    v_and_b32 v210, 256, v251
    v_cmp_ne_u32 s[36:37], 0, v210
    s_mov_b64 exec, s[36:37]
    global_load_dwordx4 v[192:195], v249, s[14:15] offset:256 sc1
    s_mov_b64 exec, -1
    v_and_b32 v210, 512, v251
    v_cmp_ne_u32 s[38:39], 0, v210
    s_mov_b64 exec, s[38:39]
    global_load_dwordx4 v[196:199], v249, s[14:15] offset:288 sc1
    s_mov_b64 exec, -1
    s_mov_b32 s42, 10
    s_branch L2_ld
L2_x0:
    s_and_b32 s39, s32, 0xff
    s_bcnt1_i32_b32 s39, s39
    s_lshr_b64 s[32:33], s[32:33], 8
    s_waitcnt lgkmcnt(0)
    s_cmp_le_u32 s39, 0
    s_cbranch_scc1 L2_w14_8
    buffer_load_dwordx4 v[192:195], v240, s[8:11], 0 offen
    s_cmp_le_u32 s39, 1
    s_cbranch_scc1 L2_w14_8
    buffer_load_dwordx4 v[196:199], v241, s[8:11], 0 offen
    s_cmp_le_u32 s39, 2
    s_cbranch_scc1 L2_w14_8
    buffer_load_dwordx4 v[200:203], v242, s[8:11], 0 offen
    s_cmp_le_u32 s39, 3
    s_cbranch_scc1 L2_w14_8
    buffer_load_dwordx4 v[204:207], v243, s[8:11], 0 offen
    s_cmp_le_u32 s39, 4
    s_cbranch_scc1 L2_w14_8
    buffer_load_dwordx4 v[208:211], v244, s[8:11], 0 offen
    s_cmp_le_u32 s39, 5
    s_cbranch_scc1 L2_w14_8
    buffer_load_dwordx4 v[212:215], v245, s[8:11], 0 offen
    s_cmp_le_u32 s39, 6
    s_cbranch_scc1 L2_w14_8
    buffer_load_dwordx4 v[216:219], v246, s[8:11], 0 offen
    s_cmp_le_u32 s39, 7
    s_cbranch_scc1 L2_w14_8
    buffer_load_dwordx4 v[220:223], v247, s[8:11], 0 offen
L2_w14_8:
    s_mov_b32 s6, 1048576
L2_wchk:
    v_cmp_ne_u32 vcc, s56, v254
    v_cmp_ne_u32 s[4:5], s58, v255
    s_or_b64 vcc, vcc, s[4:5]
    s_cbranch_scc0 L2_wok
    s_waitcnt vmcnt(0)
    v_and_b32 v254, 63, v252
    v_min_u32 v254, 39, v254
    s_and_b32 s4, s17, 3
    s_mul_i32 s4, s4, 320
    s_add_u32 s4, s4, 7864320
    v_lshl_add_u32 v254, v254, 3, s4
    global_load_dwordx2 v[254:255], v254, s[14:15] sc1
    s_sub_u32 s6, s6, 1
    s_waitcnt vmcnt(0)
    s_cbranch_scc0 L2_wchk
L2_wok:
    v_and_b32 v252, 63, v252
    v_and_b32 v254, 3, v252
    v_bfe_u32 v240, v252, 2, 2
    v_lshlrev_b32 v252, 4, v252
    v_lshlrev_b32 v249, 8, v254
    v_lshl_add_u32 v249, v240, 10, v249
    v_and_b32 v240, 1, v240
    v_mul_u32_u24 v240, 12, v240
    v_or_b32 v254, v254, v240
    v_lshlrev_b32 v254, 4, v254
    v_mov_b32 v255, v254
    v_add_u32 v251, 54272, v249
    v_mov_b32 v250, 8192
    v_mov_b32 v241, v249
    v_add_u32 v249, 37888, v249
    s_mov_b32 exec_lo, 0xffff0000
    s_mov_b32 exec_hi, 0x0
    v_add_u32 v249, 62464, v241
    v_add_u32 v251, 136192, v241
    v_mov_b32 v250, 12288
    s_mov_b32 exec_lo, 0x0
    s_mov_b32 exec_hi, 0xffff
    v_add_u32 v249, 87040, v241
    v_add_u32 v251, 136192, v241
    v_mov_b32 v250, 12288
    v_xor_b32 v255, 128, v255
    s_mov_b32 exec_lo, 0x0
    s_mov_b32 exec_hi, 0xffff0000
    v_add_u32 v249, 111616, v241
    v_add_u32 v251, 148480, v241
    v_mov_b32 v250, 12288
    s_mov_b64 exec, -1
    s_mul_i32 s51, s17, 5
    s_mov_b32 s48, 0xffff0000
    s_mov_b32 s49, -1
    s_lshr_b32 s5, s51, 4
    s_and_b32 s6, s51, 15
    s_lshl_b32 s6, s6, 4
    s_cmp_lt_u32 s51, 32
    s_cselect_b64 s[42:43], -1, 0
    v_mad_u32_u24 v240, v250, s5, v249
    v_cndmask_b32 v240, v251, v240, s[42:43]
    v_cndmask_b32 v241, v255, v254, s[42:43]
    v_xor_b32 v241, s6, v241
    v_add_u32 v240, v240, v241
    v_cvt_pk_bf16_f32 v224, v0, v4
    v_cvt_pk_bf16_f32 v225, v8, v12
    v_cvt_pk_bf16_f32 v226, v16, v20
    v_cvt_pk_bf16_f32 v227, v24, v28
    ds_write_b128 v240, v[224:227]
    v_cvt_pk_bf16_f32 v228, v1, v5
    v_cvt_pk_bf16_f32 v229, v9, v13
    v_cvt_pk_bf16_f32 v230, v17, v21
    v_cvt_pk_bf16_f32 v231, v25, v29
    ds_write_b128 v240, v[228:231] offset:4096
    v_sub_f32 v2, v2, v3
    v_sub_f32 v6, v6, v7
    v_sub_f32 v10, v10, v11
    v_sub_f32 v14, v14, v15
    v_sub_f32 v18, v18, v19
    v_sub_f32 v22, v22, v23
    v_sub_f32 v26, v26, v27
    v_sub_f32 v30, v30, v31
    v_cvt_pk_bf16_f32 v0, v2, v6
    v_cvt_pk_bf16_f32 v1, v10, v14
    v_cvt_pk_bf16_f32 v2, v18, v22
    v_cvt_pk_bf16_f32 v3, v26, v30
    s_mov_b64 exec, s[48:49]
    ds_write_b128 v240, v[0:3] offset:8192
    s_mov_b64 exec, -1
    s_add_u32 s51, s51, 1
    s_cmp_le_u32 s39, 0
    s_cbranch_scc1 L2_y0_0
    s_cmp_le_u32 s39, 1
    s_cbranch_scc1 L2_y0_1
    s_cmp_le_u32 s39, 2
    s_cbranch_scc1 L2_y0_2
    s_cmp_le_u32 s39, 3
    s_cbranch_scc1 L2_y0_3
    s_cmp_le_u32 s39, 4
    s_cbranch_scc1 L2_y0_4
    s_cmp_le_u32 s39, 5
    s_cbranch_scc1 L2_y0_5
    s_cmp_le_u32 s39, 6
    s_cbranch_scc1 L2_y0_6
    s_cmp_le_u32 s39, 7
    s_cbranch_scc1 L2_y0_7
    s_branch L2_y0_8
L2_y0_0:
    s_waitcnt vmcnt(0)
L2_y0_1:
    s_waitcnt vmcnt(1)
L2_y0_2:
    s_waitcnt vmcnt(2)
L2_y0_3:
    s_waitcnt vmcnt(3)
L2_y0_4:
    s_waitcnt vmcnt(4)
L2_y0_5:
    s_waitcnt vmcnt(5)
L2_y0_6:
    s_waitcnt vmcnt(6)
L2_y0_7:
    s_waitcnt vmcnt(7)
L2_y0_8:
    s_waitcnt vmcnt(8)
    s_branch L2_g6
L2_x1:
    s_and_b32 s38, s34, 0xff
    s_bcnt1_i32_b32 s38, s38
    s_lshr_b64 s[34:35], s[34:35], 8
    s_waitcnt lgkmcnt(0)
    s_cmp_le_u32 s38, 0
    s_cbranch_scc1 L2_w15_8
    buffer_load_dwordx4 v[160:163], v240, s[8:11], 0 offen
    s_cmp_le_u32 s38, 1
    s_cbranch_scc1 L2_w15_8
    buffer_load_dwordx4 v[164:167], v241, s[8:11], 0 offen
    s_cmp_le_u32 s38, 2
    s_cbranch_scc1 L2_w15_8
    buffer_load_dwordx4 v[168:171], v242, s[8:11], 0 offen
    s_cmp_le_u32 s38, 3
    s_cbranch_scc1 L2_w15_8
    buffer_load_dwordx4 v[172:175], v243, s[8:11], 0 offen
    s_cmp_le_u32 s38, 4
    s_cbranch_scc1 L2_w15_8
    buffer_load_dwordx4 v[176:179], v244, s[8:11], 0 offen
    s_cmp_le_u32 s38, 5
    s_cbranch_scc1 L2_w15_8
    buffer_load_dwordx4 v[180:183], v245, s[8:11], 0 offen
    s_cmp_le_u32 s38, 6
    s_cbranch_scc1 L2_w15_8
    buffer_load_dwordx4 v[184:187], v246, s[8:11], 0 offen
    s_cmp_le_u32 s38, 7
    s_cbranch_scc1 L2_w15_8
    buffer_load_dwordx4 v[188:191], v247, s[8:11], 0 offen
L2_w15_8:
    s_lshr_b32 s5, s51, 4
    s_and_b32 s6, s51, 15
    s_lshl_b32 s6, s6, 4
    s_cmp_lt_u32 s51, 32
    s_cselect_b64 s[42:43], -1, 0
    v_mad_u32_u24 v240, v250, s5, v249
    v_cndmask_b32 v240, v251, v240, s[42:43]
    v_cndmask_b32 v241, v255, v254, s[42:43]
    v_xor_b32 v241, s6, v241
    v_add_u32 v240, v240, v241
    v_cvt_pk_bf16_f32 v224, v32, v36
    v_cvt_pk_bf16_f32 v225, v40, v44
    v_cvt_pk_bf16_f32 v226, v48, v52
    v_cvt_pk_bf16_f32 v227, v56, v60
    ds_write_b128 v240, v[224:227]
    v_cvt_pk_bf16_f32 v228, v33, v37
    v_cvt_pk_bf16_f32 v229, v41, v45
    v_cvt_pk_bf16_f32 v230, v49, v53
    v_cvt_pk_bf16_f32 v231, v57, v61
    ds_write_b128 v240, v[228:231] offset:4096
    v_sub_f32 v34, v34, v35
    v_sub_f32 v38, v38, v39
    v_sub_f32 v42, v42, v43
    v_sub_f32 v46, v46, v47
    v_sub_f32 v50, v50, v51
    v_sub_f32 v54, v54, v55
    v_sub_f32 v58, v58, v59
    v_sub_f32 v62, v62, v63
    v_cvt_pk_bf16_f32 v32, v34, v38
    v_cvt_pk_bf16_f32 v33, v42, v46
    v_cvt_pk_bf16_f32 v34, v50, v54
    v_cvt_pk_bf16_f32 v35, v58, v62
    s_mov_b64 exec, s[48:49]
    ds_write_b128 v240, v[32:35] offset:8192
    s_mov_b64 exec, -1
    s_add_u32 s51, s51, 1
    s_cmp_lt_u32 s17, 4
    s_cbranch_scc1 L2_xo1
    s_cmp_le_u32 s38, 0
    s_cbranch_scc1 L2_y1_0
    s_cmp_le_u32 s38, 1
    s_cbranch_scc1 L2_y1_1
    s_cmp_le_u32 s38, 2
    s_cbranch_scc1 L2_y1_2
    s_cmp_le_u32 s38, 3
    s_cbranch_scc1 L2_y1_3
    s_cmp_le_u32 s38, 4
    s_cbranch_scc1 L2_y1_4
    s_cmp_le_u32 s38, 5
    s_cbranch_scc1 L2_y1_5
    s_cmp_le_u32 s38, 6
    s_cbranch_scc1 L2_y1_6
    s_cmp_le_u32 s38, 7
    s_cbranch_scc1 L2_y1_7
    s_branch L2_y1_8
L2_y1_0:
    s_waitcnt vmcnt(0)
L2_y1_1:
    s_waitcnt vmcnt(1)
L2_y1_2:
    s_waitcnt vmcnt(2)
L2_y1_3:
    s_waitcnt vmcnt(3)
L2_y1_4:
    s_waitcnt vmcnt(4)
L2_y1_5:
    s_waitcnt vmcnt(5)
L2_y1_6:
    s_waitcnt vmcnt(6)
L2_y1_7:
    s_waitcnt vmcnt(7)
L2_y1_8:
    s_waitcnt vmcnt(8)
    s_branch L2_g7
L2_xo1:
    s_cmp_le_u32 s38, 0
    s_cbranch_scc1 L2_z1_0
    s_cmp_le_u32 s38, 1
    s_cbranch_scc1 L2_z1_1
    s_cmp_le_u32 s38, 2
    s_cbranch_scc1 L2_z1_2
    s_cmp_le_u32 s38, 3
    s_cbranch_scc1 L2_z1_3
    s_cmp_le_u32 s38, 4
    s_cbranch_scc1 L2_z1_4
    s_cmp_le_u32 s38, 5
    s_cbranch_scc1 L2_z1_5
    s_cmp_le_u32 s38, 6
    s_cbranch_scc1 L2_z1_6
    s_cmp_le_u32 s38, 7
    s_cbranch_scc1 L2_z1_7
    s_branch L2_z1_8
L2_z1_0:
    s_waitcnt vmcnt(0)
L2_z1_1:
    s_waitcnt vmcnt(1)
L2_z1_2:
    s_waitcnt vmcnt(2)
L2_z1_3:
    s_waitcnt vmcnt(3)
L2_z1_4:
    s_waitcnt vmcnt(4)
L2_z1_5:
    s_waitcnt vmcnt(5)
L2_z1_6:
    s_waitcnt vmcnt(6)
L2_z1_7:
    s_waitcnt vmcnt(7)
L2_z1_8:
    s_waitcnt vmcnt(8)
    s_branch L2_g7
L2_x2:
    s_and_b32 s39, s36, 0xff
    s_bcnt1_i32_b32 s39, s39
    s_lshr_b64 s[36:37], s[36:37], 8
    s_waitcnt lgkmcnt(0)
    s_cmp_le_u32 s39, 0
    s_cbranch_scc1 L2_w16_8
    buffer_load_dwordx4 v[192:195], v240, s[8:11], 0 offen
    s_cmp_le_u32 s39, 1
    s_cbranch_scc1 L2_w16_8
    buffer_load_dwordx4 v[196:199], v241, s[8:11], 0 offen
    s_cmp_le_u32 s39, 2
    s_cbranch_scc1 L2_w16_8
    buffer_load_dwordx4 v[200:203], v242, s[8:11], 0 offen
    s_cmp_le_u32 s39, 3
    s_cbranch_scc1 L2_w16_8
    buffer_load_dwordx4 v[204:207], v243, s[8:11], 0 offen
    s_cmp_le_u32 s39, 4
    s_cbranch_scc1 L2_w16_8
    buffer_load_dwordx4 v[208:211], v244, s[8:11], 0 offen
    s_cmp_le_u32 s39, 5
    s_cbranch_scc1 L2_w16_8
    buffer_load_dwordx4 v[212:215], v245, s[8:11], 0 offen
    s_cmp_le_u32 s39, 6
    s_cbranch_scc1 L2_w16_8
    buffer_load_dwordx4 v[216:219], v246, s[8:11], 0 offen
    s_cmp_le_u32 s39, 7
    s_cbranch_scc1 L2_w16_8
    buffer_load_dwordx4 v[220:223], v247, s[8:11], 0 offen
L2_w16_8:
    s_lshr_b32 s5, s51, 4
    s_and_b32 s6, s51, 15
    s_lshl_b32 s6, s6, 4
    s_cmp_lt_u32 s51, 32
    s_cselect_b64 s[42:43], -1, 0
    v_mad_u32_u24 v240, v250, s5, v249
    v_cndmask_b32 v240, v251, v240, s[42:43]
    v_cndmask_b32 v241, v255, v254, s[42:43]
    v_xor_b32 v241, s6, v241
    v_add_u32 v240, v240, v241
    v_cvt_pk_bf16_f32 v224, v64, v68
    v_cvt_pk_bf16_f32 v225, v72, v76
    v_cvt_pk_bf16_f32 v226, v80, v84
    v_cvt_pk_bf16_f32 v227, v88, v92
    ds_write_b128 v240, v[224:227]
    v_cvt_pk_bf16_f32 v228, v65, v69
    v_cvt_pk_bf16_f32 v229, v73, v77
    v_cvt_pk_bf16_f32 v230, v81, v85
    v_cvt_pk_bf16_f32 v231, v89, v93
    ds_write_b128 v240, v[228:231] offset:4096
    v_sub_f32 v66, v66, v67
    v_sub_f32 v70, v70, v71
    v_sub_f32 v74, v74, v75
    v_sub_f32 v78, v78, v79
    v_sub_f32 v82, v82, v83
    v_sub_f32 v86, v86, v87
    v_sub_f32 v90, v90, v91
    v_sub_f32 v94, v94, v95
    v_cvt_pk_bf16_f32 v64, v66, v70
    v_cvt_pk_bf16_f32 v65, v74, v78
    v_cvt_pk_bf16_f32 v66, v82, v86
    v_cvt_pk_bf16_f32 v67, v90, v94
    s_mov_b64 exec, s[48:49]
    ds_write_b128 v240, v[64:67] offset:8192
    s_mov_b64 exec, -1
    s_add_u32 s51, s51, 1
    s_cmp_lt_u32 s17, 4
    s_cbranch_scc1 L2_xo2
    global_load_dwordx4 v[0:3], v252, s[26:27] offset:-4096 sc1
    global_load_dwordx4 v[4:7], v252, s[26:27] offset:-3072 sc1
    global_load_dwordx4 v[8:11], v252, s[26:27] offset:-2048 sc1
    global_load_dwordx4 v[12:15], v252, s[26:27] offset:-1024 sc1
    global_load_dwordx4 v[16:19], v252, s[26:27] offset:0 sc1
    global_load_dwordx4 v[20:23], v252, s[26:27] offset:1024 sc1
    global_load_dwordx4 v[24:27], v252, s[26:27] offset:2048 sc1
    global_load_dwordx4 v[28:31], v252, s[26:27] offset:3072 sc1
    s_cmp_le_u32 s39, 0
    s_cbranch_scc1 L2_y2_0
    s_cmp_le_u32 s39, 1
    s_cbranch_scc1 L2_y2_1
    s_cmp_le_u32 s39, 2
    s_cbranch_scc1 L2_y2_2
    s_cmp_le_u32 s39, 3
    s_cbranch_scc1 L2_y2_3
    s_cmp_le_u32 s39, 4
    s_cbranch_scc1 L2_y2_4
    s_cmp_le_u32 s39, 5
    s_cbranch_scc1 L2_y2_5
    s_cmp_le_u32 s39, 6
    s_cbranch_scc1 L2_y2_6
    s_cmp_le_u32 s39, 7
    s_cbranch_scc1 L2_y2_7
    s_branch L2_y2_8
L2_y2_0:
    s_waitcnt vmcnt(8)
L2_y2_1:
    s_waitcnt vmcnt(9)
L2_y2_2:
    s_waitcnt vmcnt(10)
L2_y2_3:
    s_waitcnt vmcnt(11)
L2_y2_4:
    s_waitcnt vmcnt(12)
L2_y2_5:
    s_waitcnt vmcnt(13)
L2_y2_6:
    s_waitcnt vmcnt(14)
L2_y2_7:
    s_waitcnt vmcnt(15)
L2_y2_8:
    s_waitcnt vmcnt(16)
    s_branch L2_g8
L2_xo2:
    s_cmp_le_u32 s39, 0
    s_cbranch_scc1 L2_z2_0
    s_cmp_le_u32 s39, 1
    s_cbranch_scc1 L2_z2_1
    s_cmp_le_u32 s39, 2
    s_cbranch_scc1 L2_z2_2
    s_cmp_le_u32 s39, 3
    s_cbranch_scc1 L2_z2_3
    s_cmp_le_u32 s39, 4
    s_cbranch_scc1 L2_z2_4
    s_cmp_le_u32 s39, 5
    s_cbranch_scc1 L2_z2_5
    s_cmp_le_u32 s39, 6
    s_cbranch_scc1 L2_z2_6
    s_cmp_le_u32 s39, 7
    s_cbranch_scc1 L2_z2_7
    s_branch L2_z2_8
L2_z2_0:
    s_waitcnt vmcnt(0)
L2_z2_1:
    s_waitcnt vmcnt(1)
L2_z2_2:
    s_waitcnt vmcnt(2)
L2_z2_3:
    s_waitcnt vmcnt(3)
L2_z2_4:
    s_waitcnt vmcnt(4)
L2_z2_5:
    s_waitcnt vmcnt(5)
L2_z2_6:
    s_waitcnt vmcnt(6)
L2_z2_7:
    s_waitcnt vmcnt(7)
L2_z2_8:
    s_waitcnt vmcnt(8)
    s_branch L2_g8
L2_x3:
    s_waitcnt lgkmcnt(0)
    s_lshr_b32 s5, s51, 4
    s_and_b32 s6, s51, 15
    s_lshl_b32 s6, s6, 4
    s_cmp_lt_u32 s51, 32
    s_cselect_b64 s[42:43], -1, 0
    v_mad_u32_u24 v240, v250, s5, v249
    v_cndmask_b32 v240, v251, v240, s[42:43]
    v_cndmask_b32 v241, v255, v254, s[42:43]
    v_xor_b32 v241, s6, v241
    v_add_u32 v240, v240, v241
    v_cvt_pk_bf16_f32 v224, v96, v100
    v_cvt_pk_bf16_f32 v225, v104, v108
    v_cvt_pk_bf16_f32 v226, v112, v116
    v_cvt_pk_bf16_f32 v227, v120, v124
    ds_write_b128 v240, v[224:227]
    v_cvt_pk_bf16_f32 v228, v97, v101
    v_cvt_pk_bf16_f32 v229, v105, v109
    v_cvt_pk_bf16_f32 v230, v113, v117
    v_cvt_pk_bf16_f32 v231, v121, v125
    ds_write_b128 v240, v[228:231] offset:4096
    v_sub_f32 v98, v98, v99
    v_sub_f32 v102, v102, v103
    v_sub_f32 v106, v106, v107
    v_sub_f32 v110, v110, v111
    v_sub_f32 v114, v114, v115
    v_sub_f32 v118, v118, v119
    v_sub_f32 v122, v122, v123
    v_sub_f32 v126, v126, v127
    v_cvt_pk_bf16_f32 v96, v98, v102
    v_cvt_pk_bf16_f32 v97, v106, v110
    v_cvt_pk_bf16_f32 v98, v114, v118
    v_cvt_pk_bf16_f32 v99, v122, v126
    s_mov_b64 exec, s[48:49]
    ds_write_b128 v240, v[96:99] offset:8192
    s_mov_b64 exec, -1
    s_add_u32 s51, s51, 1
    s_cmp_lt_u32 s17, 4
    s_cbranch_scc1 L2_xo3
    s_add_u32 s26, s26, 8192
    s_addc_u32 s27, s27, 0
    global_load_dwordx4 v[32:35], v252, s[26:27] offset:-4096 sc1
    global_load_dwordx4 v[36:39], v252, s[26:27] offset:-3072 sc1
    global_load_dwordx4 v[40:43], v252, s[26:27] offset:-2048 sc1
    global_load_dwordx4 v[44:47], v252, s[26:27] offset:-1024 sc1
    global_load_dwordx4 v[48:51], v252, s[26:27] offset:0 sc1
    global_load_dwordx4 v[52:55], v252, s[26:27] offset:1024 sc1
    global_load_dwordx4 v[56:59], v252, s[26:27] offset:2048 sc1
    global_load_dwordx4 v[60:63], v252, s[26:27] offset:3072 sc1
    v_lshrrev_b32 v86, 8, v252
    v_bfe_u32 v87, v252, 4, 4
    v_xor_b32 v80, v87, v86
    v_lshlrev_b32 v80, 4, v80
    v_lshl_add_u32 v80, v86, 8, v80
    v_xor_b32 v81, 0xc0, v80
    v_add_u32 v82, 103424, v80
    v_add_u32 v83, 103424, v81
    v_add_u32 v80, 37888, v80
    v_add_u32 v81, 37888, v81
    v_lshlrev_b32 v84, 10, v87
    v_lshl_add_u32 v84, v86, 4, v84
    v_mov_b32 v85, v84
    s_mov_b32 exec_lo, 0xff00ff00
    s_mov_b32 exec_hi, 0xff00ff00
    v_add_u32 v85, -7936, v85
    s_mov_b64 exec, -1
    s_waitcnt vmcnt(16)
    s_branch L2_g9
L2_xo3:
    s_waitcnt vmcnt(0)
    s_branch L2_g9
L2_x4:
    s_waitcnt lgkmcnt(0)
    s_cmp_lt_u32 s17, 4
    s_cbranch_scc1 L2_xw4
    s_add_u32 s26, s26, 8192
    s_addc_u32 s27, s27, 0
    global_load_dwordx4 v[64:67], v252, s[26:27] offset:-4096 sc1
    global_load_dwordx4 v[68:71], v252, s[26:27] offset:-3072 sc1
    global_load_dwordx4 v[72:75], v252, s[26:27] offset:-2048 sc1
    global_load_dwordx4 v[76:79], v252, s[26:27] offset:-1024 sc1
    global_load_dwordx4 v[160:163], v252, s[26:27] offset:0 sc1
    global_load_dwordx4 v[164:167], v252, s[26:27] offset:1024 sc1
    global_load_dwordx4 v[168:171], v252, s[26:27] offset:2048 sc1
    global_load_dwordx4 v[172:175], v252, s[26:27] offset:3072 sc1
    s_add_u32 s26, s26, 8192
    s_addc_u32 s27, s27, 0
    global_load_dwordx4 v[176:179], v252, s[26:27] offset:-4096 sc1
    global_load_dwordx4 v[180:183], v252, s[26:27] offset:-3072 sc1
    global_load_dwordx4 v[184:187], v252, s[26:27] offset:-2048 sc1
    global_load_dwordx4 v[188:191], v252, s[26:27] offset:-1024 sc1
    global_load_dwordx4 v[192:195], v252, s[26:27] offset:0 sc1
    global_load_dwordx4 v[196:199], v252, s[26:27] offset:1024 sc1
    global_load_dwordx4 v[200:203], v252, s[26:27] offset:2048 sc1
    global_load_dwordx4 v[204:207], v252, s[26:27] offset:3072 sc1
    s_add_u32 s26, s26, 8192
    s_addc_u32 s27, s27, 0
    global_load_dwordx4 v[208:211], v252, s[26:27] offset:-4096 sc1
    global_load_dwordx4 v[212:215], v252, s[26:27] offset:-3072 sc1
    global_load_dwordx4 v[216:219], v252, s[26:27] offset:-2048 sc1
    global_load_dwordx4 v[220:223], v252, s[26:27] offset:-1024 sc1
L2_xw4:
    s_lshr_b32 s5, s51, 4
    s_and_b32 s6, s51, 15
    s_lshl_b32 s6, s6, 4
    s_cmp_lt_u32 s51, 32
    s_cselect_b64 s[42:43], -1, 0
    v_mad_u32_u24 v240, v250, s5, v249
    v_cndmask_b32 v240, v251, v240, s[42:43]
    v_cndmask_b32 v241, v255, v254, s[42:43]
    v_xor_b32 v241, s6, v241
    v_add_u32 v240, v240, v241
    v_cvt_pk_bf16_f32 v224, v128, v132
    v_cvt_pk_bf16_f32 v225, v136, v140
    v_cvt_pk_bf16_f32 v226, v144, v148
    v_cvt_pk_bf16_f32 v227, v152, v156
    ds_write_b128 v240, v[224:227]
    v_cvt_pk_bf16_f32 v228, v129, v133
    v_cvt_pk_bf16_f32 v229, v137, v141
    v_cvt_pk_bf16_f32 v230, v145, v149
    v_cvt_pk_bf16_f32 v231, v153, v157
    ds_write_b128 v240, v[228:231] offset:4096
    v_sub_f32 v130, v130, v131
    v_sub_f32 v134, v134, v135
    v_sub_f32 v138, v138, v139
    v_sub_f32 v142, v142, v143
    v_sub_f32 v146, v146, v147
    v_sub_f32 v150, v150, v151
    v_sub_f32 v154, v154, v155
    v_sub_f32 v158, v158, v159
    v_cvt_pk_bf16_f32 v128, v130, v134
    v_cvt_pk_bf16_f32 v129, v138, v142
    v_cvt_pk_bf16_f32 v130, v146, v150
    v_cvt_pk_bf16_f32 v131, v154, v158
    s_mov_b64 exec, s[48:49]
    ds_write_b128 v240, v[128:131] offset:8192
    s_mov_b64 exec, -1
    s_add_u32 s51, s51, 1
    s_waitcnt lgkmcnt(0)
    s_cmp_lt_u32 s17, 4
    s_cbranch_scc0 L2_gemm
    s_barrier
    s_endpgm
L2_gemm:
    global_load_dwordx4 v[224:227], v252, s[26:27] offset:0 sc1
    global_load_dwordx4 v[228:231], v252, s[26:27] offset:1024 sc1
    global_load_dwordx4 v[232:235], v252, s[26:27] offset:2048 sc1
    global_load_dwordx4 v[236:239], v252, s[26:27] offset:3072 sc1
    s_barrier
    ds_read_b128 v[136:139], v80 offset:0
    ds_read_b128 v[140:143], v81 offset:1024
    ds_read_b128 v[144:147], v80 offset:2048
    ds_read_b128 v[148:151], v81 offset:3072
    ds_read_b128 v[152:155], v80 offset:4096
    ds_read_b128 v[156:159], v81 offset:5120
    s_waitcnt vmcnt(36)
    s_waitcnt lgkmcnt(4)
    v_mfma_f32_16x16x32_bf16 v[96:99], v[0:3], v[136:139], 0
    ds_read_b128 v[240:243], v80 offset:6144
    v_mfma_f32_16x16x32_bf16 v[100:103], v[4:7], v[136:139], 0
    v_mfma_f32_16x16x32_bf16 v[96:99], v[8:11], v[140:143], v[96:99]
    ds_read_b128 v[244:247], v81 offset:7168
    v_mfma_f32_16x16x32_bf16 v[100:103], v[12:15], v[140:143], v[100:103]
    s_waitcnt vmcnt(32)
    s_waitcnt lgkmcnt(4)
    v_mfma_f32_16x16x32_bf16 v[96:99], v[16:19], v[144:147], v[96:99]
    ds_read_b128 v[136:139], v80 offset:8192
    v_mfma_f32_16x16x32_bf16 v[100:103], v[20:23], v[144:147], v[100:103]
    v_mfma_f32_16x16x32_bf16 v[96:99], v[24:27], v[148:151], v[96:99]
    ds_read_b128 v[140:143], v81 offset:9216
    v_mfma_f32_16x16x32_bf16 v[100:103], v[28:31], v[148:151], v[100:103]
    s_waitcnt vmcnt(28)
    s_waitcnt lgkmcnt(4)
    v_mfma_f32_16x16x32_bf16 v[96:99], v[32:35], v[152:155], v[96:99]
    ds_read_b128 v[144:147], v80 offset:10240
    v_mfma_f32_16x16x32_bf16 v[100:103], v[36:39], v[152:155], v[100:103]
    v_mfma_f32_16x16x32_bf16 v[96:99], v[40:43], v[156:159], v[96:99]
    ds_read_b128 v[148:151], v81 offset:11264
    v_mfma_f32_16x16x32_bf16 v[100:103], v[44:47], v[156:159], v[100:103]
    s_waitcnt vmcnt(24)
    s_waitcnt lgkmcnt(4)
    v_mfma_f32_16x16x32_bf16 v[96:99], v[48:51], v[240:243], v[96:99]
    ds_read_b128 v[152:155], v80 offset:12288
    v_mfma_f32_16x16x32_bf16 v[100:103], v[52:55], v[240:243], v[100:103]
    v_mfma_f32_16x16x32_bf16 v[96:99], v[56:59], v[244:247], v[96:99]
    ds_read_b128 v[156:159], v81 offset:13312
    v_mfma_f32_16x16x32_bf16 v[100:103], v[60:63], v[244:247], v[100:103]
    s_waitcnt lgkmcnt(4)
    v_mfma_f32_16x16x32_bf16 v[104:107], v[0:3], v[136:139], 0
    ds_read_b128 v[240:243], v80 offset:14336
    v_mfma_f32_16x16x32_bf16 v[108:111], v[4:7], v[136:139], 0
    v_mfma_f32_16x16x32_bf16 v[104:107], v[8:11], v[140:143], v[104:107]
    ds_read_b128 v[244:247], v81 offset:15360
    v_mfma_f32_16x16x32_bf16 v[108:111], v[12:15], v[140:143], v[108:111]
    s_waitcnt lgkmcnt(4)
    v_mfma_f32_16x16x32_bf16 v[104:107], v[16:19], v[144:147], v[104:107]
    ds_read_b128 v[136:139], v80 offset:16384
    v_cvt_pk_bf16_f32 v88, v96, v97
    v_mfma_f32_16x16x32_bf16 v[108:111], v[20:23], v[144:147], v[108:111]
    v_cvt_pk_bf16_f32 v89, v98, v99
    v_cvt_pk_bf16_f32 v90, v100, v101
    v_mfma_f32_16x16x32_bf16 v[104:107], v[24:27], v[148:151], v[104:107]
    ds_read_b128 v[140:143], v81 offset:17408
    v_cvt_pk_bf16_f32 v91, v102, v103
    v_mfma_f32_16x16x32_bf16 v[108:111], v[28:31], v[148:151], v[108:111]
    global_store_dwordx4 v84, v[88:91], s[20:21] offset:0 sc1
    v_mul_f32 v96, 0xbfb8aa3b, v96
    s_waitcnt lgkmcnt(4)
    v_mfma_f32_16x16x32_bf16 v[104:107], v[32:35], v[152:155], v[104:107]
    ds_read_b128 v[144:147], v80 offset:18432
    v_mul_f32 v97, 0xbfb8aa3b, v97
    v_mfma_f32_16x16x32_bf16 v[108:111], v[36:39], v[152:155], v[108:111]
    v_mul_f32 v98, 0xbfb8aa3b, v98
    v_mul_f32 v99, 0xbfb8aa3b, v99
    v_mfma_f32_16x16x32_bf16 v[104:107], v[40:43], v[156:159], v[104:107]
    ds_read_b128 v[148:151], v81 offset:19456
    v_mul_f32 v100, 0xbfb8aa3b, v100
    v_mfma_f32_16x16x32_bf16 v[108:111], v[44:47], v[156:159], v[108:111]
    v_mul_f32 v101, 0xbfb8aa3b, v101
    v_mul_f32 v102, 0xbfb8aa3b, v102
    s_waitcnt lgkmcnt(4)
    v_mfma_f32_16x16x32_bf16 v[104:107], v[48:51], v[240:243], v[104:107]
    ds_read_b128 v[152:155], v80 offset:20480
    v_mul_f32 v103, 0xbfb8aa3b, v103
    v_mfma_f32_16x16x32_bf16 v[108:111], v[52:55], v[240:243], v[108:111]
    v_exp_f32 v96, v96
    v_mfma_f32_16x16x32_bf16 v[104:107], v[56:59], v[244:247], v[104:107]
    ds_read_b128 v[156:159], v81 offset:21504
    v_exp_f32 v97, v97
    v_mfma_f32_16x16x32_bf16 v[108:111], v[60:63], v[244:247], v[108:111]
    v_exp_f32 v98, v98
    s_waitcnt lgkmcnt(4)
    v_mfma_f32_16x16x32_bf16 v[112:115], v[0:3], v[136:139], 0
    ds_read_b128 v[240:243], v80 offset:22528
    v_exp_f32 v99, v99
    v_mfma_f32_16x16x32_bf16 v[116:119], v[4:7], v[136:139], 0
    v_exp_f32 v100, v100
    v_mfma_f32_16x16x32_bf16 v[112:115], v[8:11], v[140:143], v[112:115]
    ds_read_b128 v[244:247], v81 offset:23552
    v_exp_f32 v101, v101
    v_mfma_f32_16x16x32_bf16 v[116:119], v[12:15], v[140:143], v[116:119]
    s_waitcnt lgkmcnt(4)
    v_mfma_f32_16x16x32_bf16 v[112:115], v[16:19], v[144:147], v[112:115]
    ds_read_b128 v[136:139], v80 offset:24576
    v_exp_f32 v102, v102
    v_mfma_f32_16x16x32_bf16 v[116:119], v[20:23], v[144:147], v[116:119]
    v_exp_f32 v103, v103
    v_mfma_f32_16x16x32_bf16 v[112:115], v[24:27], v[148:151], v[112:115]
    ds_read_b128 v[140:143], v81 offset:25600
    v_add_f32 v96, 1.0, v96
    v_mfma_f32_16x16x32_bf16 v[116:119], v[28:31], v[148:151], v[116:119]
    v_add_f32 v97, 1.0, v97
    s_waitcnt lgkmcnt(4)
    v_mfma_f32_16x16x32_bf16 v[112:115], v[32:35], v[152:155], v[112:115]
    ds_read_b128 v[144:147], v80 offset:26624
    v_add_f32 v98, 1.0, v98
    v_mfma_f32_16x16x32_bf16 v[116:119], v[36:39], v[152:155], v[116:119]
    v_add_f32 v99, 1.0, v99
    v_add_f32 v100, 1.0, v100
    v_mfma_f32_16x16x32_bf16 v[112:115], v[40:43], v[156:159], v[112:115]
    ds_read_b128 v[148:151], v81 offset:27648
    v_add_f32 v101, 1.0, v101
    v_mfma_f32_16x16x32_bf16 v[116:119], v[44:47], v[156:159], v[116:119]
    v_add_f32 v102, 1.0, v102
    v_add_f32 v103, 1.0, v103
    s_waitcnt lgkmcnt(4)
    v_mfma_f32_16x16x32_bf16 v[112:115], v[48:51], v[240:243], v[112:115]
    ds_read_b128 v[152:155], v80 offset:28672
    v_rcp_f32 v96, v96
    v_mfma_f32_16x16x32_bf16 v[116:119], v[52:55], v[240:243], v[116:119]
    v_rcp_f32 v97, v97
    v_mfma_f32_16x16x32_bf16 v[112:115], v[56:59], v[244:247], v[112:115]
    ds_read_b128 v[156:159], v81 offset:29696
    v_rcp_f32 v98, v98
    v_mfma_f32_16x16x32_bf16 v[116:119], v[60:63], v[244:247], v[116:119]
    s_waitcnt vmcnt(21)
    s_waitcnt lgkmcnt(4)
    v_mfma_f32_16x16x32_bf16 v[128:131], v[64:67], v[136:139], 0
    ds_read_b128 v[240:243], v80 offset:30720
    v_rcp_f32 v99, v99
    v_mfma_f32_16x16x32_bf16 v[132:135], v[68:71], v[136:139], 0
    v_rcp_f32 v100, v100
    v_mfma_f32_16x16x32_bf16 v[128:131], v[72:75], v[140:143], v[128:131]
    ds_read_b128 v[244:247], v81 offset:31744
    v_rcp_f32 v101, v101
    v_mfma_f32_16x16x32_bf16 v[132:135], v[76:79], v[140:143], v[132:135]
    s_waitcnt vmcnt(17)
    s_waitcnt lgkmcnt(4)
    v_mfma_f32_16x16x32_bf16 v[128:131], v[160:163], v[144:147], v[128:131]
    ds_read_b128 v[136:139], v80 offset:32768
    v_rcp_f32 v102, v102
    v_mfma_f32_16x16x32_bf16 v[132:135], v[164:167], v[144:147], v[132:135]
    v_rcp_f32 v103, v103
    v_mfma_f32_16x16x32_bf16 v[128:131], v[168:171], v[148:151], v[128:131]
    ds_read_b128 v[140:143], v81 offset:33792
    v_cvt_pk_bf16_f32 v92, v104, v105
    v_mfma_f32_16x16x32_bf16 v[132:135], v[172:175], v[148:151], v[132:135]
    v_cvt_pk_bf16_f32 v93, v106, v107
    s_waitcnt vmcnt(13)
    s_waitcnt lgkmcnt(4)
    v_mfma_f32_16x16x32_bf16 v[128:131], v[176:179], v[152:155], v[128:131]
    ds_read_b128 v[144:147], v80 offset:34816
    v_cvt_pk_bf16_f32 v94, v108, v109
    v_mfma_f32_16x16x32_bf16 v[132:135], v[180:183], v[152:155], v[132:135]
    v_cvt_pk_bf16_f32 v95, v110, v111
    global_store_dwordx4 v84, v[92:95], s[22:23] offset:0 sc1
    v_mfma_f32_16x16x32_bf16 v[128:131], v[184:187], v[156:159], v[128:131]
    ds_read_b128 v[148:151], v81 offset:35840
    v_cvt_pk_bf16_f32 v88, v112, v113
    v_mfma_f32_16x16x32_bf16 v[132:135], v[188:191], v[156:159], v[132:135]
    v_cvt_pk_bf16_f32 v89, v114, v115
    v_cvt_pk_bf16_f32 v90, v116, v117
    s_waitcnt vmcnt(10)
    s_waitcnt lgkmcnt(4)
    v_mfma_f32_16x16x32_bf16 v[128:131], v[192:195], v[240:243], v[128:131]
    ds_read_b128 v[152:155], v80 offset:49152
    v_cvt_pk_bf16_f32 v91, v118, v119
    v_mfma_f32_16x16x32_bf16 v[132:135], v[196:199], v[240:243], v[132:135]
    s_mov_b64 exec, s[52:53]
    global_store_dwordx4 v84, v[88:91], s[24:25] offset:0 sc1
    s_mov_b64 exec, -1
    v_mfma_f32_16x16x32_bf16 v[128:131], v[200:203], v[244:247], v[128:131]
    ds_read_b128 v[156:159], v81 offset:50176
    v_mfma_f32_16x16x32_bf16 v[132:135], v[204:207], v[244:247], v[132:135]
    s_waitcnt vmcnt(7)
    s_waitcnt lgkmcnt(4)
    v_mfma_f32_16x16x32_bf16 v[128:131], v[208:211], v[136:139], v[128:131]
    ds_read_b128 v[240:243], v80 offset:51200
    v_mfma_f32_16x16x32_bf16 v[132:135], v[212:215], v[136:139], v[132:135]
    v_mfma_f32_16x16x32_bf16 v[128:131], v[216:219], v[140:143], v[128:131]
    ds_read_b128 v[244:247], v81 offset:52224
    v_mfma_f32_16x16x32_bf16 v[132:135], v[220:223], v[140:143], v[132:135]
    s_waitcnt vmcnt(3)
    s_waitcnt lgkmcnt(4)
    v_mfma_f32_16x16x32_bf16 v[128:131], v[224:227], v[144:147], v[128:131]
    ds_read_b128 v[136:139], v80 offset:53248
    v_mfma_f32_16x16x32_bf16 v[132:135], v[228:231], v[144:147], v[132:135]
    v_mfma_f32_16x16x32_bf16 v[128:131], v[232:235], v[148:151], v[128:131]
    ds_read_b128 v[140:143], v81 offset:54272
    v_mfma_f32_16x16x32_bf16 v[132:135], v[236:239], v[148:151], v[132:135]
    s_waitcnt lgkmcnt(4)
    v_mfma_f32_16x16x32_bf16 v[120:123], v[64:67], v[152:155], 0
    ds_read_b128 v[144:147], v80 offset:55296
    v_mfma_f32_16x16x32_bf16 v[124:127], v[68:71], v[152:155], 0
    v_mfma_f32_16x16x32_bf16 v[120:123], v[72:75], v[156:159], v[120:123]
    ds_read_b128 v[148:151], v81 offset:56320
    v_mfma_f32_16x16x32_bf16 v[124:127], v[76:79], v[156:159], v[124:127]
    s_waitcnt lgkmcnt(4)
    v_mfma_f32_16x16x32_bf16 v[120:123], v[160:163], v[240:243], v[120:123]
    ds_read_b128 v[152:155], v80 offset:57344
    v_mul_f32 v128, v128, v96
    v_mfma_f32_16x16x32_bf16 v[124:127], v[164:167], v[240:243], v[124:127]
    v_mul_f32 v129, v129, v97
    v_mul_f32 v130, v130, v98
    v_mfma_f32_16x16x32_bf16 v[120:123], v[168:171], v[244:247], v[120:123]
    ds_read_b128 v[156:159], v81 offset:58368
    v_mul_f32 v131, v131, v99
    v_mfma_f32_16x16x32_bf16 v[124:127], v[172:175], v[244:247], v[124:127]
    v_mul_f32 v132, v132, v100
    v_mul_f32 v133, v133, v101
    s_waitcnt lgkmcnt(4)
    v_mfma_f32_16x16x32_bf16 v[120:123], v[176:179], v[136:139], v[120:123]
    ds_read_b128 v[240:243], v80 offset:59392
    v_mul_f32 v134, v134, v102
    v_mfma_f32_16x16x32_bf16 v[124:127], v[180:183], v[136:139], v[124:127]
    v_mul_f32 v135, v135, v103
    v_cvt_pk_bf16_f32 v92, v128, v129
    v_mfma_f32_16x16x32_bf16 v[120:123], v[184:187], v[140:143], v[120:123]
    ds_read_b128 v[244:247], v81 offset:60416
    v_cvt_pk_bf16_f32 v93, v130, v131
    v_mfma_f32_16x16x32_bf16 v[124:127], v[188:191], v[140:143], v[124:127]
    v_cvt_pk_bf16_f32 v94, v132, v133
    v_cvt_pk_bf16_f32 v95, v134, v135
    s_waitcnt lgkmcnt(4)
    v_mfma_f32_16x16x32_bf16 v[120:123], v[192:195], v[144:147], v[120:123]
    ds_read_b128 v[136:139], v82 offset:8192
    global_store_dwordx4 v84, v[92:95], s[20:21] offset:256 sc1
    v_mfma_f32_16x16x32_bf16 v[124:127], v[196:199], v[144:147], v[124:127]
    v_mul_f32 v104, 0xbfb8aa3b, v104
    v_mul_f32 v105, 0xbfb8aa3b, v105
    v_mfma_f32_16x16x32_bf16 v[120:123], v[200:203], v[148:151], v[120:123]
    ds_read_b128 v[140:143], v83 offset:9216
    v_mul_f32 v106, 0xbfb8aa3b, v106
    v_mfma_f32_16x16x32_bf16 v[124:127], v[204:207], v[148:151], v[124:127]
    v_mul_f32 v107, 0xbfb8aa3b, v107
    v_mul_f32 v108, 0xbfb8aa3b, v108
    s_waitcnt lgkmcnt(4)
    v_mfma_f32_16x16x32_bf16 v[120:123], v[208:211], v[152:155], v[120:123]
    ds_read_b128 v[144:147], v82 offset:10240
    v_mul_f32 v109, 0xbfb8aa3b, v109
    v_mfma_f32_16x16x32_bf16 v[124:127], v[212:215], v[152:155], v[124:127]
    v_mul_f32 v110, 0xbfb8aa3b, v110
    v_mul_f32 v111, 0xbfb8aa3b, v111
    v_mfma_f32_16x16x32_bf16 v[120:123], v[216:219], v[156:159], v[120:123]
    ds_read_b128 v[148:151], v83 offset:11264
    v_exp_f32 v104, v104
    v_mfma_f32_16x16x32_bf16 v[124:127], v[220:223], v[156:159], v[124:127]
    v_exp_f32 v105, v105
    s_waitcnt lgkmcnt(4)
    v_mfma_f32_16x16x32_bf16 v[120:123], v[224:227], v[240:243], v[120:123]
    ds_read_b128 v[152:155], v82 offset:12288
    v_exp_f32 v106, v106
    v_mfma_f32_16x16x32_bf16 v[124:127], v[228:231], v[240:243], v[124:127]
    v_exp_f32 v107, v107
    v_mfma_f32_16x16x32_bf16 v[120:123], v[232:235], v[244:247], v[120:123]
    ds_read_b128 v[156:159], v83 offset:13312
    v_exp_f32 v108, v108
    v_mfma_f32_16x16x32_bf16 v[124:127], v[236:239], v[244:247], v[124:127]
    s_waitcnt lgkmcnt(4)
    v_mfma_f32_16x16x32_bf16 v[128:131], v[64:67], v[136:139], 0
    ds_read_b128 v[240:243], v82 offset:14336
    v_exp_f32 v109, v109
    v_mfma_f32_16x16x32_bf16 v[132:135], v[68:71], v[136:139], 0
    v_exp_f32 v110, v110
    v_mfma_f32_16x16x32_bf16 v[128:131], v[72:75], v[140:143], v[128:131]
    ds_read_b128 v[244:247], v83 offset:15360
    v_exp_f32 v111, v111
    v_mfma_f32_16x16x32_bf16 v[132:135], v[76:79], v[140:143], v[132:135]
    s_waitcnt lgkmcnt(4)
    v_mfma_f32_16x16x32_bf16 v[128:131], v[160:163], v[144:147], v[128:131]
    ds_read_b128 v[136:139], v82 offset:16384
    v_mul_f32 v120, v120, v96
    v_mfma_f32_16x16x32_bf16 v[132:135], v[164:167], v[144:147], v[132:135]
    v_mul_f32 v121, v121, v97
    v_mul_f32 v122, v122, v98
    v_mfma_f32_16x16x32_bf16 v[128:131], v[168:171], v[148:151], v[128:131]
    ds_read_b128 v[140:143], v83 offset:17408
    v_mul_f32 v123, v123, v99
    v_mfma_f32_16x16x32_bf16 v[132:135], v[172:175], v[148:151], v[132:135]
    v_mul_f32 v124, v124, v100
    v_mul_f32 v125, v125, v101
    s_waitcnt lgkmcnt(4)
    v_mfma_f32_16x16x32_bf16 v[128:131], v[176:179], v[152:155], v[128:131]
    ds_read_b128 v[144:147], v82 offset:18432
    v_mul_f32 v126, v126, v102
    v_mfma_f32_16x16x32_bf16 v[132:135], v[180:183], v[152:155], v[132:135]
    v_mul_f32 v127, v127, v103
    v_cvt_pk_bf16_f32 v88, v120, v121
    v_mfma_f32_16x16x32_bf16 v[128:131], v[184:187], v[156:159], v[128:131]
    ds_read_b128 v[148:151], v83 offset:19456
    v_cvt_pk_bf16_f32 v89, v122, v123
    v_mfma_f32_16x16x32_bf16 v[132:135], v[188:191], v[156:159], v[132:135]
    v_cvt_pk_bf16_f32 v90, v124, v125
    v_cvt_pk_bf16_f32 v91, v126, v127
    s_waitcnt lgkmcnt(4)
    v_mfma_f32_16x16x32_bf16 v[128:131], v[192:195], v[240:243], v[128:131]
    ds_read_b128 v[152:155], v80 offset:36864
    global_store_dwordx4 v84, v[88:91], s[20:21] offset:512 sc1
    v_mfma_f32_16x16x32_bf16 v[132:135], v[196:199], v[240:243], v[132:135]
    v_add_f32 v104, 1.0, v104
    v_add_f32 v105, 1.0, v105
    v_mfma_f32_16x16x32_bf16 v[128:131], v[200:203], v[244:247], v[128:131]
    ds_read_b128 v[156:159], v81 offset:37888
    v_add_f32 v106, 1.0, v106
    v_mfma_f32_16x16x32_bf16 v[132:135], v[204:207], v[244:247], v[132:135]
    v_add_f32 v107, 1.0, v107
    v_add_f32 v108, 1.0, v108
    s_waitcnt lgkmcnt(4)
    v_mfma_f32_16x16x32_bf16 v[128:131], v[208:211], v[136:139], v[128:131]
    ds_read_b128 v[240:243], v80 offset:38912
    v_add_f32 v109, 1.0, v109
    v_mfma_f32_16x16x32_bf16 v[132:135], v[212:215], v[136:139], v[132:135]
    v_add_f32 v110, 1.0, v110
    v_add_f32 v111, 1.0, v111
    v_mfma_f32_16x16x32_bf16 v[128:131], v[216:219], v[140:143], v[128:131]
    ds_read_b128 v[244:247], v81 offset:39936
    v_rcp_f32 v104, v104
    v_mfma_f32_16x16x32_bf16 v[132:135], v[220:223], v[140:143], v[132:135]
    v_rcp_f32 v105, v105
    s_waitcnt lgkmcnt(4)
    v_mfma_f32_16x16x32_bf16 v[128:131], v[224:227], v[144:147], v[128:131]
    ds_read_b128 v[136:139], v80 offset:40960
    v_rcp_f32 v106, v106
    v_mfma_f32_16x16x32_bf16 v[132:135], v[228:231], v[144:147], v[132:135]
    v_mfma_f32_16x16x32_bf16 v[128:131], v[232:235], v[148:151], v[128:131]
    ds_read_b128 v[140:143], v81 offset:41984
    v_rcp_f32 v107, v107
    v_mfma_f32_16x16x32_bf16 v[132:135], v[236:239], v[148:151], v[132:135]
    v_rcp_f32 v108, v108
    s_waitcnt lgkmcnt(4)
    v_mfma_f32_16x16x32_bf16 v[120:123], v[64:67], v[152:155], 0
    ds_read_b128 v[144:147], v80 offset:43008
    v_rcp_f32 v109, v109
    v_mfma_f32_16x16x32_bf16 v[124:127], v[68:71], v[152:155], 0
    v_mfma_f32_16x16x32_bf16 v[120:123], v[72:75], v[156:159], v[120:123]
    ds_read_b128 v[148:151], v81 offset:44032
    v_rcp_f32 v110, v110
    v_mfma_f32_16x16x32_bf16 v[124:127], v[76:79], v[156:159], v[124:127]
    v_rcp_f32 v111, v111
    s_waitcnt lgkmcnt(4)
    v_mfma_f32_16x16x32_bf16 v[120:123], v[160:163], v[240:243], v[120:123]
    ds_read_b128 v[152:155], v80 offset:45056
    v_mul_f32 v128, v128, v96
    v_mfma_f32_16x16x32_bf16 v[124:127], v[164:167], v[240:243], v[124:127]
    v_mul_f32 v129, v129, v97
    v_mfma_f32_16x16x32_bf16 v[120:123], v[168:171], v[244:247], v[120:123]
    ds_read_b128 v[156:159], v81 offset:46080
    v_mul_f32 v130, v130, v98
    v_mfma_f32_16x16x32_bf16 v[124:127], v[172:175], v[244:247], v[124:127]
    v_mul_f32 v131, v131, v99
    v_mul_f32 v132, v132, v100
    s_waitcnt lgkmcnt(4)
    v_mfma_f32_16x16x32_bf16 v[120:123], v[176:179], v[136:139], v[120:123]
    ds_read_b128 v[240:243], v80 offset:47104
    v_mul_f32 v133, v133, v101
    v_mfma_f32_16x16x32_bf16 v[124:127], v[180:183], v[136:139], v[124:127]
    v_mul_f32 v134, v134, v102
    v_mul_f32 v135, v135, v103
    v_mfma_f32_16x16x32_bf16 v[120:123], v[184:187], v[140:143], v[120:123]
    ds_read_b128 v[244:247], v81 offset:48128
    v_cvt_pk_bf16_f32 v92, v128, v129
    v_mfma_f32_16x16x32_bf16 v[124:127], v[188:191], v[140:143], v[124:127]
    v_cvt_pk_bf16_f32 v93, v130, v131
    v_cvt_pk_bf16_f32 v94, v132, v133
    s_waitcnt lgkmcnt(4)
    v_mfma_f32_16x16x32_bf16 v[120:123], v[192:195], v[144:147], v[120:123]
    ds_read_b128 v[136:139], v80 offset:61440
    v_cvt_pk_bf16_f32 v95, v134, v135
    v_mfma_f32_16x16x32_bf16 v[124:127], v[196:199], v[144:147], v[124:127]
    global_store_dwordx4 v84, v[92:95], s[20:21] offset:768 sc1
    v_mul_f32 v112, 0xbfb8aa3b, v112
    v_mfma_f32_16x16x32_bf16 v[120:123], v[200:203], v[148:151], v[120:123]
    ds_read_b128 v[140:143], v81 offset:62464
    v_mul_f32 v113, 0xbfb8aa3b, v113
    v_mfma_f32_16x16x32_bf16 v[124:127], v[204:207], v[148:151], v[124:127]
    v_mul_f32 v114, 0xbfb8aa3b, v114
    v_mul_f32 v115, 0xbfb8aa3b, v115
    s_waitcnt lgkmcnt(4)
    v_mfma_f32_16x16x32_bf16 v[120:123], v[208:211], v[152:155], v[120:123]
    ds_read_b128 v[144:147], v80 offset:63488
    v_mul_f32 v116, 0xbfb8aa3b, v116
    v_mfma_f32_16x16x32_bf16 v[124:127], v[212:215], v[152:155], v[124:127]
    v_mul_f32 v117, 0xbfb8aa3b, v117
    v_mul_f32 v118, 0xbfb8aa3b, v118
    v_mfma_f32_16x16x32_bf16 v[120:123], v[216:219], v[156:159], v[120:123]
    ds_read_b128 v[148:151], v81 offset:64512
    v_mul_f32 v119, 0xbfb8aa3b, v119
    v_mfma_f32_16x16x32_bf16 v[124:127], v[220:223], v[156:159], v[124:127]
    v_exp_f32 v112, v112
    s_waitcnt lgkmcnt(4)
    v_mfma_f32_16x16x32_bf16 v[120:123], v[224:227], v[240:243], v[120:123]
    ds_read_b128 v[152:155], v82 offset:0
    v_exp_f32 v113, v113
    v_mfma_f32_16x16x32_bf16 v[124:127], v[228:231], v[240:243], v[124:127]
    v_exp_f32 v114, v114
    v_mfma_f32_16x16x32_bf16 v[120:123], v[232:235], v[244:247], v[120:123]
    ds_read_b128 v[156:159], v83 offset:1024
    v_exp_f32 v115, v115
    v_mfma_f32_16x16x32_bf16 v[124:127], v[236:239], v[244:247], v[124:127]
    s_waitcnt lgkmcnt(4)
    v_mfma_f32_16x16x32_bf16 v[128:131], v[64:67], v[136:139], 0
    ds_read_b128 v[240:243], v82 offset:2048
    v_exp_f32 v116, v116
    v_mfma_f32_16x16x32_bf16 v[132:135], v[68:71], v[136:139], 0
    v_exp_f32 v117, v117
    v_mfma_f32_16x16x32_bf16 v[128:131], v[72:75], v[140:143], v[128:131]
    ds_read_b128 v[244:247], v83 offset:3072
    v_mfma_f32_16x16x32_bf16 v[132:135], v[76:79], v[140:143], v[132:135]
    s_waitcnt lgkmcnt(4)
    v_mfma_f32_16x16x32_bf16 v[128:131], v[160:163], v[144:147], v[128:131]
    ds_read_b128 v[136:139], v82 offset:4096
    v_mul_f32 v120, v120, v104
    v_mfma_f32_16x16x32_bf16 v[132:135], v[164:167], v[144:147], v[132:135]
    v_mul_f32 v121, v121, v105
    v_mul_f32 v122, v122, v106
    v_mfma_f32_16x16x32_bf16 v[128:131], v[168:171], v[148:151], v[128:131]
    ds_read_b128 v[140:143], v83 offset:5120
    v_mul_f32 v123, v123, v107
    v_mfma_f32_16x16x32_bf16 v[132:135], v[172:175], v[148:151], v[132:135]
    v_mul_f32 v124, v124, v108
    v_mul_f32 v125, v125, v109
    s_waitcnt lgkmcnt(4)
    v_mfma_f32_16x16x32_bf16 v[128:131], v[176:179], v[152:155], v[128:131]
    ds_read_b128 v[144:147], v82 offset:6144
    v_mul_f32 v126, v126, v110
    v_mfma_f32_16x16x32_bf16 v[132:135], v[180:183], v[152:155], v[132:135]
    v_mul_f32 v127, v127, v111
    v_cvt_pk_bf16_f32 v88, v120, v121
    v_mfma_f32_16x16x32_bf16 v[128:131], v[184:187], v[156:159], v[128:131]
    ds_read_b128 v[148:151], v83 offset:7168
    v_cvt_pk_bf16_f32 v89, v122, v123
    v_mfma_f32_16x16x32_bf16 v[132:135], v[188:191], v[156:159], v[132:135]
    v_cvt_pk_bf16_f32 v90, v124, v125
    v_cvt_pk_bf16_f32 v91, v126, v127
    s_waitcnt lgkmcnt(4)
    v_mfma_f32_16x16x32_bf16 v[128:131], v[192:195], v[240:243], v[128:131]
    ds_read_b128 v[152:155], v82 offset:20480
    global_store_dwordx4 v84, v[88:91], s[22:23] offset:256 sc1
    v_mfma_f32_16x16x32_bf16 v[132:135], v[196:199], v[240:243], v[132:135]
    v_exp_f32 v118, v118
    v_mfma_f32_16x16x32_bf16 v[128:131], v[200:203], v[244:247], v[128:131]
    ds_read_b128 v[156:159], v83 offset:21504
    v_exp_f32 v119, v119
    v_mfma_f32_16x16x32_bf16 v[132:135], v[204:207], v[244:247], v[132:135]
    v_add_f32 v112, 1.0, v112
    v_add_f32 v113, 1.0, v113
    s_waitcnt lgkmcnt(4)
    v_mfma_f32_16x16x32_bf16 v[128:131], v[208:211], v[136:139], v[128:131]
    ds_read_b128 v[240:243], v82 offset:22528
    v_add_f32 v114, 1.0, v114
    v_mfma_f32_16x16x32_bf16 v[132:135], v[212:215], v[136:139], v[132:135]
    v_add_f32 v115, 1.0, v115
    v_add_f32 v116, 1.0, v116
    v_mfma_f32_16x16x32_bf16 v[128:131], v[216:219], v[140:143], v[128:131]
    ds_read_b128 v[244:247], v83 offset:23552
    v_add_f32 v117, 1.0, v117
    v_mfma_f32_16x16x32_bf16 v[132:135], v[220:223], v[140:143], v[132:135]
    v_add_f32 v118, 1.0, v118
    v_add_f32 v119, 1.0, v119
    s_waitcnt lgkmcnt(4)
    v_mfma_f32_16x16x32_bf16 v[128:131], v[224:227], v[144:147], v[128:131]
    ds_read_b128 v[136:139], v82 offset:24576
    v_rcp_f32 v112, v112
    v_mfma_f32_16x16x32_bf16 v[132:135], v[228:231], v[144:147], v[132:135]
    v_rcp_f32 v113, v113
    v_mfma_f32_16x16x32_bf16 v[128:131], v[232:235], v[148:151], v[128:131]
    ds_read_b128 v[140:143], v83 offset:25600
    v_rcp_f32 v114, v114
    v_mfma_f32_16x16x32_bf16 v[132:135], v[236:239], v[148:151], v[132:135]
    s_waitcnt lgkmcnt(4)
    v_mfma_f32_16x16x32_bf16 v[120:123], v[64:67], v[152:155], 0
    ds_read_b128 v[144:147], v82 offset:26624
    v_rcp_f32 v115, v115
    v_mfma_f32_16x16x32_bf16 v[124:127], v[68:71], v[152:155], 0
    v_mfma_f32_16x16x32_bf16 v[120:123], v[72:75], v[156:159], v[120:123]
    ds_read_b128 v[148:151], v83 offset:27648
    v_mfma_f32_16x16x32_bf16 v[124:127], v[76:79], v[156:159], v[124:127]
    s_waitcnt lgkmcnt(4)
    v_mfma_f32_16x16x32_bf16 v[120:123], v[160:163], v[240:243], v[120:123]
    ds_read_b128 v[152:155], v82 offset:28672
    v_mul_f32 v128, v128, v104
    v_mfma_f32_16x16x32_bf16 v[124:127], v[164:167], v[240:243], v[124:127]
    v_mul_f32 v129, v129, v105
    v_mul_f32 v130, v130, v106
    v_mfma_f32_16x16x32_bf16 v[120:123], v[168:171], v[244:247], v[120:123]
    ds_read_b128 v[156:159], v83 offset:29696
    v_mul_f32 v131, v131, v107
    v_mfma_f32_16x16x32_bf16 v[124:127], v[172:175], v[244:247], v[124:127]
    v_mul_f32 v132, v132, v108
    v_mul_f32 v133, v133, v109
    s_waitcnt lgkmcnt(4)
    v_mfma_f32_16x16x32_bf16 v[120:123], v[176:179], v[136:139], v[120:123]
    ds_read_b128 v[240:243], v82 offset:30720
    v_mul_f32 v134, v134, v110
    v_mfma_f32_16x16x32_bf16 v[124:127], v[180:183], v[136:139], v[124:127]
    v_mul_f32 v135, v135, v111
    v_cvt_pk_bf16_f32 v92, v128, v129
    v_mfma_f32_16x16x32_bf16 v[120:123], v[184:187], v[140:143], v[120:123]
    ds_read_b128 v[244:247], v83 offset:31744
    v_cvt_pk_bf16_f32 v93, v130, v131
    v_mfma_f32_16x16x32_bf16 v[124:127], v[188:191], v[140:143], v[124:127]
    v_cvt_pk_bf16_f32 v94, v132, v133
    v_cvt_pk_bf16_f32 v95, v134, v135
    s_waitcnt lgkmcnt(4)
    v_mfma_f32_16x16x32_bf16 v[120:123], v[192:195], v[144:147], v[120:123]
    ds_read_b128 v[136:139], v82 offset:32768
    global_store_dwordx4 v84, v[92:95], s[22:23] offset:512 sc1
    v_mfma_f32_16x16x32_bf16 v[124:127], v[196:199], v[144:147], v[124:127]
    v_rcp_f32 v116, v116
    v_mfma_f32_16x16x32_bf16 v[120:123], v[200:203], v[148:151], v[120:123]
    ds_read_b128 v[140:143], v83 offset:33792
    v_rcp_f32 v117, v117
    v_mfma_f32_16x16x32_bf16 v[124:127], v[204:207], v[148:151], v[124:127]
    v_rcp_f32 v118, v118
    s_waitcnt lgkmcnt(4)
    v_mfma_f32_16x16x32_bf16 v[120:123], v[208:211], v[152:155], v[120:123]
    ds_read_b128 v[144:147], v82 offset:34816
    v_rcp_f32 v119, v119
    v_mfma_f32_16x16x32_bf16 v[124:127], v[212:215], v[152:155], v[124:127]
    v_mov_b32_dpp v112, v112 row_shr:8 row_mask:0xf bank_mask:0xc
    v_mfma_f32_16x16x32_bf16 v[120:123], v[216:219], v[156:159], v[120:123]
    ds_read_b128 v[148:151], v83 offset:35840
    v_mov_b32_dpp v113, v113 row_shr:8 row_mask:0xf bank_mask:0xc
    v_mfma_f32_16x16x32_bf16 v[124:127], v[220:223], v[156:159], v[124:127]
    v_mov_b32_dpp v114, v114 row_shr:8 row_mask:0xf bank_mask:0xc
    v_mov_b32_dpp v115, v115 row_shr:8 row_mask:0xf bank_mask:0xc
    s_waitcnt lgkmcnt(4)
    v_mfma_f32_16x16x32_bf16 v[120:123], v[224:227], v[240:243], v[120:123]
    ds_read_b128 v[152:155], v82 offset:36864
    v_mov_b32_dpp v116, v116 row_shr:8 row_mask:0xf bank_mask:0xc
    v_mfma_f32_16x16x32_bf16 v[124:127], v[228:231], v[240:243], v[124:127]
    v_mov_b32_dpp v117, v117 row_shr:8 row_mask:0xf bank_mask:0xc
    v_mov_b32_dpp v118, v118 row_shr:8 row_mask:0xf bank_mask:0xc
    v_mfma_f32_16x16x32_bf16 v[120:123], v[232:235], v[244:247], v[120:123]
    ds_read_b128 v[156:159], v83 offset:37888
    v_mov_b32_dpp v119, v119 row_shr:8 row_mask:0xf bank_mask:0xc
    v_mfma_f32_16x16x32_bf16 v[124:127], v[236:239], v[244:247], v[124:127]
    s_waitcnt lgkmcnt(4)
    v_mfma_f32_16x16x32_bf16 v[128:131], v[64:67], v[136:139], 0
    ds_read_b128 v[240:243], v82 offset:38912
    v_mfma_f32_16x16x32_bf16 v[132:135], v[68:71], v[136:139], 0
    v_mfma_f32_16x16x32_bf16 v[128:131], v[72:75], v[140:143], v[128:131]
    ds_read_b128 v[244:247], v83 offset:39936
    v_mfma_f32_16x16x32_bf16 v[132:135], v[76:79], v[140:143], v[132:135]
    s_waitcnt lgkmcnt(4)
    v_mfma_f32_16x16x32_bf16 v[128:131], v[160:163], v[144:147], v[128:131]
    ds_read_b128 v[136:139], v82 offset:40960
    v_mul_f32 v120, v120, v104
    v_mfma_f32_16x16x32_bf16 v[132:135], v[164:167], v[144:147], v[132:135]
    v_mul_f32 v121, v121, v105
    v_mul_f32 v122, v122, v106
    v_mfma_f32_16x16x32_bf16 v[128:131], v[168:171], v[148:151], v[128:131]
    ds_read_b128 v[140:143], v83 offset:41984
    v_mul_f32 v123, v123, v107
    v_mfma_f32_16x16x32_bf16 v[132:135], v[172:175], v[148:151], v[132:135]
    v_mul_f32 v124, v124, v108
    v_mul_f32 v125, v125, v109
    s_waitcnt lgkmcnt(4)
    v_mfma_f32_16x16x32_bf16 v[128:131], v[176:179], v[152:155], v[128:131]
    ds_read_b128 v[144:147], v82 offset:43008
    v_mul_f32 v126, v126, v110
    v_mfma_f32_16x16x32_bf16 v[132:135], v[180:183], v[152:155], v[132:135]
    v_mul_f32 v127, v127, v111
    v_cvt_pk_bf16_f32 v88, v120, v121
    v_mfma_f32_16x16x32_bf16 v[128:131], v[184:187], v[156:159], v[128:131]
    ds_read_b128 v[148:151], v83 offset:44032
    v_cvt_pk_bf16_f32 v89, v122, v123
    v_mfma_f32_16x16x32_bf16 v[132:135], v[188:191], v[156:159], v[132:135]
    v_cvt_pk_bf16_f32 v90, v124, v125
    v_cvt_pk_bf16_f32 v91, v126, v127
    s_waitcnt lgkmcnt(4)
    v_mfma_f32_16x16x32_bf16 v[128:131], v[192:195], v[240:243], v[128:131]
    ds_read_b128 v[152:155], v82 offset:45056
    global_store_dwordx4 v84, v[88:91], s[22:23] offset:768 sc1
    v_mfma_f32_16x16x32_bf16 v[132:135], v[196:199], v[240:243], v[132:135]
    v_mfma_f32_16x16x32_bf16 v[128:131], v[200:203], v[244:247], v[128:131]
    ds_read_b128 v[156:159], v83 offset:46080
    v_mfma_f32_16x16x32_bf16 v[132:135], v[204:207], v[244:247], v[132:135]
    s_waitcnt lgkmcnt(4)
    v_mfma_f32_16x16x32_bf16 v[128:131], v[208:211], v[136:139], v[128:131]
    ds_read_b128 v[240:243], v82 offset:47104
    v_mfma_f32_16x16x32_bf16 v[132:135], v[212:215], v[136:139], v[132:135]
    v_mfma_f32_16x16x32_bf16 v[128:131], v[216:219], v[140:143], v[128:131]
    ds_read_b128 v[244:247], v83 offset:48128
    v_mfma_f32_16x16x32_bf16 v[132:135], v[220:223], v[140:143], v[132:135]
    s_waitcnt lgkmcnt(4)
    v_mfma_f32_16x16x32_bf16 v[128:131], v[224:227], v[144:147], v[128:131]
    ds_read_b128 v[136:139], v82 offset:49152
    v_mfma_f32_16x16x32_bf16 v[132:135], v[228:231], v[144:147], v[132:135]
    v_mfma_f32_16x16x32_bf16 v[128:131], v[232:235], v[148:151], v[128:131]
    ds_read_b128 v[140:143], v83 offset:50176
    v_mfma_f32_16x16x32_bf16 v[132:135], v[236:239], v[148:151], v[132:135]
    s_waitcnt lgkmcnt(4)
    v_mfma_f32_16x16x32_bf16 v[120:123], v[64:67], v[152:155], 0
    ds_read_b128 v[144:147], v82 offset:51200
    v_mfma_f32_16x16x32_bf16 v[124:127], v[68:71], v[152:155], 0
    v_mfma_f32_16x16x32_bf16 v[120:123], v[72:75], v[156:159], v[120:123]
    ds_read_b128 v[148:151], v83 offset:52224
    v_mfma_f32_16x16x32_bf16 v[124:127], v[76:79], v[156:159], v[124:127]
    s_waitcnt lgkmcnt(4)
    v_mfma_f32_16x16x32_bf16 v[120:123], v[160:163], v[240:243], v[120:123]
    ds_read_b128 v[152:155], v82 offset:53248
    v_mul_f32 v128, v128, v112
    v_mfma_f32_16x16x32_bf16 v[124:127], v[164:167], v[240:243], v[124:127]
    v_mul_f32 v129, v129, v113
    v_mul_f32 v130, v130, v114
    v_mfma_f32_16x16x32_bf16 v[120:123], v[168:171], v[244:247], v[120:123]
    ds_read_b128 v[156:159], v83 offset:54272
    v_mul_f32 v131, v131, v115
    v_mfma_f32_16x16x32_bf16 v[124:127], v[172:175], v[244:247], v[124:127]
    v_mul_f32 v132, v132, v116
    v_mul_f32 v133, v133, v117
    s_waitcnt lgkmcnt(4)
    v_mfma_f32_16x16x32_bf16 v[120:123], v[176:179], v[136:139], v[120:123]
    ds_read_b128 v[240:243], v82 offset:55296
    v_mul_f32 v134, v134, v118
    v_mfma_f32_16x16x32_bf16 v[124:127], v[180:183], v[136:139], v[124:127]
    v_mul_f32 v135, v135, v119
    v_cvt_pk_bf16_f32 v92, v128, v129
    v_mfma_f32_16x16x32_bf16 v[120:123], v[184:187], v[140:143], v[120:123]
    ds_read_b128 v[244:247], v83 offset:56320
    v_cvt_pk_bf16_f32 v93, v130, v131
    v_mfma_f32_16x16x32_bf16 v[124:127], v[188:191], v[140:143], v[124:127]
    v_cvt_pk_bf16_f32 v94, v132, v133
    v_cvt_pk_bf16_f32 v95, v134, v135
    s_waitcnt lgkmcnt(4)
    v_mfma_f32_16x16x32_bf16 v[120:123], v[192:195], v[144:147], v[120:123]
    s_mov_b64 exec, s[54:55]
    global_store_dwordx4 v85, v[92:95], s[24:25] offset:256 sc1
    s_mov_b64 exec, -1
    v_mfma_f32_16x16x32_bf16 v[124:127], v[196:199], v[144:147], v[124:127]
    v_mfma_f32_16x16x32_bf16 v[120:123], v[200:203], v[148:151], v[120:123]
    v_mfma_f32_16x16x32_bf16 v[124:127], v[204:207], v[148:151], v[124:127]
    s_waitcnt lgkmcnt(2)
    v_mfma_f32_16x16x32_bf16 v[120:123], v[208:211], v[152:155], v[120:123]
    v_mfma_f32_16x16x32_bf16 v[124:127], v[212:215], v[152:155], v[124:127]
    v_mfma_f32_16x16x32_bf16 v[120:123], v[216:219], v[156:159], v[120:123]
    v_mfma_f32_16x16x32_bf16 v[124:127], v[220:223], v[156:159], v[124:127]
    s_waitcnt lgkmcnt(0)
    v_mfma_f32_16x16x32_bf16 v[120:123], v[224:227], v[240:243], v[120:123]
    v_mfma_f32_16x16x32_bf16 v[124:127], v[228:231], v[240:243], v[124:127]
    v_mfma_f32_16x16x32_bf16 v[120:123], v[232:235], v[244:247], v[120:123]
    v_mfma_f32_16x16x32_bf16 v[124:127], v[236:239], v[244:247], v[124:127]
    s_nop 7
    v_mul_f32 v120, v120, v112
    v_mul_f32 v121, v121, v113
    v_mul_f32 v122, v122, v114
    v_mul_f32 v123, v123, v115
    v_mul_f32 v124, v124, v116
    v_mul_f32 v125, v125, v117
    v_mul_f32 v126, v126, v118
    v_mul_f32 v127, v127, v119
    v_cvt_pk_bf16_f32 v88, v120, v121
    v_cvt_pk_bf16_f32 v89, v122, v123
    v_cvt_pk_bf16_f32 v90, v124, v125
    v_cvt_pk_bf16_f32 v91, v126, v127
    s_mov_b64 exec, s[52:53]
    global_store_dwordx4 v84, v[88:91], s[24:25] offset:768 sc1
    s_mov_b64 exec, -1
L2_fin:
L2_end:
    s_endpgm
.fill (28672 + 256 - (L2_end - gather_scatter__tensor_product_equiv_equiformer__graph_kernel)) / 4, 4, 0xbf810000
.section .rodata,"a"
.p2align 6
.amdhsa_kernel gather_scatter__tensor_product_equiv_equiformer__graph_kernel
  .amdhsa_next_free_vgpr 256
  .amdhsa_next_free_sgpr 64
  .amdhsa_accum_offset 256
  .amdhsa_group_segment_fixed_size 0
  .amdhsa_kernarg_size 96
  .amdhsa_user_sgpr_count 2
  .amdhsa_user_sgpr_kernarg_segment_ptr 1
  .amdhsa_system_sgpr_workgroup_id_x 1
.end_amdhsa_kernel
```
